```python
import torch

def _softmax(x, axis=-1):
    return torch.softmax(x, dim=axis)
def _gelu(x):
    return torch.nn.functional.gelu(x, approximate="tanh")
def _silu(x):
    return torch.nn.functional.silu(x)
def _sigmoid(x):
    return torch.sigmoid(x)
def _layernorm(x, axis=-1, eps=1e-5):
    m = x.mean(dim=axis, keepdim=True)
    v = x.var(dim=axis, keepdim=True, unbiased=False)
    return (x - m) / torch.sqrt(v + eps)
def _scatter_add(tgt, idx, src, axis=0):
    return tgt.clone().index_add_(axis, idx, src)
def _segment_sum(src, seg, n):
    out = torch.zeros((n,) + src.shape[1:], dtype=src.dtype)
    return out.index_add_(0, seg, src)
def _pad(x, pw):
    flat = tuple(v for pair in reversed(pw) for v in pair)
    return torch.nn.functional.pad(x, flat)

kernel_name = 'sequential_preLN__sliding_block_cached__mixer_channel_mlp__decode'

def setup_inputs():

    _w = (lambda a: (lambda t: t.to(torch.bfloat16) if t.is_floating_point() else t)(torch.as_tensor(a)))
    def _A_setup():
        B, Sq, D = 1, 1, 576
        Hq, Hkv, Sk, Dh = 32, 16, 65536, 128
        assert Hq % Hkv == 0, (Hq, Hkv)
        return {
            "x": _w((lambda *s: torch.randn(*s, dtype=torch.bfloat16) * 0.05)(B, Sq, D)),
            "k_cache": _w((lambda *s: torch.randn(*s, dtype=torch.bfloat16) * 3.2)(B, Hkv, Sk, Dh)),
            "v_cache": _w((lambda *s: torch.randn(*s, dtype=torch.bfloat16) * 0.4)(B, Hkv, Sk, Dh)),
            "wq": _w((lambda *s: torch.randn(*s, dtype=torch.bfloat16) * 3.2)(D, Hq * Dh) * (D ** -0.5)),
            "wo": _w((lambda *s: torch.randn(*s, dtype=torch.bfloat16) * 0.4)(Hq * Dh, D) * ((Hq * Dh) ** -0.5)),
        }
    _A_in = _A_setup()

    def _B_setup():
        B, S, D, F = 1, 1, 576, 4608
        return {
            "x": _w((lambda *s: torch.randn(*s, dtype=torch.bfloat16) * 0.05)(B, S, D)),
            "w1": _w((lambda *s: torch.randn(*s, dtype=torch.bfloat16) * 3.2)(D, F) * (D ** -0.5)),
            "b1": _w((lambda *s: torch.randn(*s, dtype=torch.bfloat16) * 3.2)(F)),
            "w2": _w((lambda *s: torch.randn(*s, dtype=torch.bfloat16) * 0.1)(F, D) * (F ** -0.5)),
            "b2": _w((lambda *s: torch.randn(*s, dtype=torch.bfloat16) * 0.1)(D)),
        }
    _B_in = _B_setup()

    return {
        "A_x": _A_in["x"],
        "A_k_cache": _A_in["k_cache"],
        "A_v_cache": _A_in["v_cache"],
        "A_wq": _A_in["wq"],
        "A_wo": _A_in["wo"],
        "B_x": _B_in["x"],
        "B_w1": _B_in["w1"],
        "B_b1": _B_in["b1"],
        "B_w2": _B_in["w2"],
        "B_b2": _B_in["b2"],
    }

def reference(A_x, A_k_cache, A_v_cache, A_wq, A_wo, B_x, B_w1, B_b1, B_w2, B_b2):
    def _A_ref(x, k_cache, v_cache, wq, wo):
        B, Sq, D = x.shape
        Hq, Dh = 32, 128
        Hkv, Sk = k_cache.shape[1], k_cache.shape[2]
        W = min(4096, max(256, Sk // 4))
        rep = Hq // Hkv
        q = (lambda x, *d: x.permute(*d))((x @ wq).reshape(B, Sq, Hq, Dh), 0, 2, 1, 3)
        k = (lambda x, n, axis: torch.repeat_interleave(x, n, dim=axis))(k_cache[:, :, Sk - W:, :], rep, axis=1)
        v = (lambda x, n, axis: torch.repeat_interleave(x, n, dim=axis))(v_cache[:, :, Sk - W:, :], rep, axis=1)
        scores = torch.einsum("bhqd,bhkd->bhqk", q, k) * (Dh ** -0.5)
        p = _softmax(scores, axis=-1)
        o = torch.einsum("bhqk,bhkd->bhqd", p, v)
        return (lambda x, *d: x.permute(*d))(o, 0, 2, 1, 3).reshape(B, Sq, Hq * Dh) @ wo

    def _B_ref(x, w1, b1, w2, b2):
        y = _layernorm(x, axis=-1)
        h = _gelu(torch.einsum("bsd,df->bsf", y, w1) + b1)
        return torch.einsum("bsf,fd->bsd", h, w2) + b2

    x = A_x
    h = x + _A_ref(_layernorm(x, axis=-1), A_k_cache, A_v_cache, A_wq, A_wo)
    h2 = h + _B_ref(_layernorm(h, axis=-1), B_w1, B_b1, B_w2, B_b2)
    return h2
```

```asm
; @launch grid=(256,1,1) block=(576,1,1) lds=16384
.amdgcn_target "amdgcn-amd-amdhsa--gfx950"
.text
.globl sequential_preLN__sliding_block_cached__mixer_channel_mlp__decode_kernel
.p2align 8
.type sequential_preLN__sliding_block_cached__mixer_channel_mlp__decode_kernel,@function
sequential_preLN__sliding_block_cached__mixer_channel_mlp__decode_kernel:
    s_cmp_ge_u32 s2, 0x100
    s_cbranch_scc1 L_end
    s_load_dwordx16 s[4:19], s[0:1], 0
    s_load_dwordx8 s[20:27], s[0:1], 64
    s_load_dwordx2 s[28:29], s[0:1], 96
    s_getpc_b64 s[60:61]
L_pc:
    v_lshlrev_b32 v12, 7, v0
    v_min_u32 v12, L_end-L_pc, v12
    v_mov_b32 v14, s60
    v_mov_b32 v15, s61
    v_add_co_u32 v14, vcc, v14, v12
    v_lshrrev_b32 v13, 6, v0
    v_and_b32 v1, 63, v0
    v_addc_co_u32 v15, vcc, 0, v15, vcc
    v_readfirstlane_b32 s3, v13
    global_load_dword v167, v[14:15], off
    s_lshr_b32 m0, s2, 4
    s_mov_b32 s80, 0xe60cde00
    s_mov_b32 s81, 0x4ca3ed98
    s_mov_b32 s82, 0x5cb554ac
    s_mov_b32 s83, 0x6cc764be
    s_mov_b32 s84, 0x7bd974d0
    s_mov_b32 s85, 0x02e783e0
    s_mov_b32 s86, 0x12f10aec
    s_mov_b32 s87, 0x22fb1af6
    s_mov_b32 s88, 0xfd8bf580
    s_mov_b32 s89, 0x949f8c96
    s_mov_b32 s90, 0xa4b19ca8
    s_mov_b32 s91, 0xb4c3acba
    s_mov_b32 s92, 0xc4d5bccc
    s_mov_b32 s93, 0xd3e5cbde
    s_mov_b32 s94, 0x32f12aec
    s_mov_b32 s95, 0x42fb3af6
    s_movrels_b32 s62, s80
    s_lshl_b32 s59, s2, 1
    s_and_b32 s59, s59, 16
    s_lshr_b32 s62, s62, s59
    s_bfe_u32 s37, s62, 0x40007
    s_bfe_u32 s38, s62, 0x5000b
    s_and_b32 s62, s62, 127
    s_and_b32 s42, s2, 7
    s_lshr_b32 s41, s2, 3
    s_lshr_b32 s39, s41, 4
    s_lshl1_add_u32 s39, s42, s39
    s_and_b32 s40, s41, 15
    s_lshr_b32 s59, s40, 2
    s_mul_i32 s59, s59, 144
    s_lshl4_add_u32 s59, s3, s59
    s_lshl_b32 s60, s59, 13
    s_lshl_b32 s61, s39, 9
    s_add_u32 s60, s60, s61
    s_and_b32 s61, s40, 3
    s_lshl_b32 s61, s61, 7
    s_add_u32 s60, s60, s61
    s_lshl_b32 s59, s59, 1
    s_lshl_b32 s61, s39, 24
    s_lshl_b32 s62, s62, 13
    s_add_u32 s61, s61, s62
    s_and_b32 s62, s3, 7
    s_mul_i32 s62, s62, s37
    s_lshl_b32 s62, s62, 10
    s_add_u32 s61, s61, s62
    s_add_u32 s61, s61, 0xf00000
    s_lshl_b32 s62, s37, 8
    v_lshrrev_b32 v12, 3, v1
    v_and_b32 v13, 7, v1
    v_lshlrev_b32 v13, 4, v13
    v_lshlrev_b32 v14, 4, v1
    v_lshlrev_b32 v15, 1, v1
    v_lshl_add_u32 v160, v12, 2, s59
    v_lshl_add_u32 v161, v12, 14, v13
    v_lshrrev_b32 v6, 4, v1
    v_and_b32 v162, 0xf0, v14
    v_mad_u32_u24 v6, v6, s62, v162
    s_waitcnt lgkmcnt(0)
    s_load_dword s30, s[28:29], 0
    global_load_dwordx4 v[120:123], v14, s[4:5]
    global_load_ushort v124, v15, s[4:5] offset:1024
    global_load_dword v125, v160, s[4:5]
    s_add_u32 s48, s10, s60
    s_addc_u32 s49, s11, 0
    global_load_dwordx4 v[112:115], v161, s[48:49] nt
    s_add_u32 s50, s48, 0x2000
    s_addc_u32 s51, s49, 0
    global_load_dwordx4 v[116:119], v161, s[50:51] nt
    s_add_u32 s44, s6, s61
    s_addc_u32 s45, s7, 0
    s_add_u32 s46, s8, s61
    s_addc_u32 s47, s9, 0
    s_cmp_eq_u32 s3, 8
    s_cbranch_scc1 L_w8_pre
    s_barrier
    global_load_dwordx4 v[16:19], v6, s[44:45] offset:0 nt
    global_load_dwordx4 v[20:23], v6, s[44:45] offset:256 nt
    s_branch L_pre_join
L_w8_pre:
    s_lshl4_add_u32 s59, s39, s40
    s_lshl_b32 s60, s59, 8
    s_add_u32 s60, s60, 0x10000
    v_lshl_add_u32 v21, v1, 7, s60
    s_lshl_b32 s60, s59, 10
    s_add_u32 s60, s60, 0x3ff00
    s_mov_b64 exec, -4
    v_lshl_add_u32 v21, v1, 7, s60
    s_lshl_b32 s60, s59, 4
    s_add_u32 s60, s60, 0x30000
    s_lshl_b64 exec, -1, 10
    v_mov_b32 v21, s60
    s_mov_b64 exec, 0x7ff
    global_load_dword v18, v21, s[28:29] sc1
    s_mov_b64 exec, 1
    global_load_dword v18, v21, s[28:29] sc1
    s_mov_b64 exec, -1
    s_barrier
    v_mov_b32 v20, 0
    v_mov_b32 v21, -1.0
    v_lshlrev_b32 v22, 2, v1
    v_lshlrev_b32 v23, 3, v1
    ds_write2st64_b32 v22, v20, v20 offset0:28 offset1:29
    ds_write2st64_b32 v22, v20, v20 offset0:30 offset1:31
    ds_write_b64 v23, v[20:21] offset:6400
L_pre_join:
    s_mov_b64 s[0:1], s[28:29]
    s_add_u32 s100, s28, 0x200000
    s_addc_u32 s101, s29, 0
    v_and_b32 v162, 3, v1
    v_lshlrev_b32 v162, 4, v162
    v_mov_b32 v164, 0xffff
    v_mov_b32 v165, 0
    v_lshlrev_b64 v[164:165], v162, v[164:165]
    v_bfe_i32 v162, v1, 2, 1
    v_and_b32 v4, v164, v162
    v_and_b32 v5, v165, v162
    v_xor_b32 v2, v164, v4
    v_xor_b32 v3, v165, v5
    v_lshrrev_b32 v7, 5, v1
    v_mul_u32_u24 v7, 320, v7
    v_lshl_add_u32 v7, v13, 1, v7
    v_and_b32 v162, 16, v1
    s_mul_i32 s59, s3, 640
    v_add3_u32 v7, v7, v162, s59
    s_mov_b32 s56, 0x00ff00ff
    s_mov_b32 s57, 0xff00ff00
    s_mov_b32 s98, 0x01010101
    s_mov_b32 s99, 0x01010101
    s_mov_b32 s35, 0x3fb8aa3b
    s_mov_b32 s36, 0x3f803f80
    v_mov_b32 v166, 0x3ae38e39
    s_waitcnt vmcnt(5)
    v_dot2_f32_bf16 v162, v120, s36, 0
    v_dot2_f32_bf16 v163, v120, v120, 0
    v_dot2_f32_bf16 v162, v121, s36, v162
    v_dot2_f32_bf16 v163, v121, v121, v163
    v_dot2_f32_bf16 v162, v122, s36, v162
    v_dot2_f32_bf16 v163, v122, v122, v163
    v_dot2_f32_bf16 v162, v123, s36, v162
    v_dot2_f32_bf16 v163, v123, v123, v163
    v_dot2_f32_bf16 v162, v124, s36, v162
    v_dot2_f32_bf16 v163, v124, v124, v163
    s_nop 1
    v_add_f32_dpp v162, v162, v162 quad_perm:[1,0,3,2] row_mask:0xf bank_mask:0xf
    v_add_f32_dpp v163, v163, v163 quad_perm:[1,0,3,2] row_mask:0xf bank_mask:0xf
    s_nop 0
    v_add_f32_dpp v162, v162, v162 quad_perm:[2,3,0,1] row_mask:0xf bank_mask:0xf
    v_add_f32_dpp v163, v163, v163 quad_perm:[2,3,0,1] row_mask:0xf bank_mask:0xf
    s_nop 0
    v_add_f32_dpp v162, v162, v162 row_half_mirror row_mask:0xf bank_mask:0xf
    v_add_f32_dpp v163, v163, v163 row_half_mirror row_mask:0xf bank_mask:0xf
    s_nop 0
    v_add_f32_dpp v162, v162, v162 row_mirror row_mask:0xf bank_mask:0xf
    v_add_f32_dpp v163, v163, v163 row_mirror row_mask:0xf bank_mask:0xf
    s_nop 0
    v_add_f32_dpp v162, v162, v162 row_bcast:15 row_mask:0xa bank_mask:0xf
    v_add_f32_dpp v163, v163, v163 row_bcast:15 row_mask:0xa bank_mask:0xf
    s_nop 0
    v_add_f32_dpp v162, v162, v162 row_bcast:31 row_mask:0xc bank_mask:0xf
    v_add_f32_dpp v163, v163, v163 row_bcast:31 row_mask:0xc bank_mask:0xf
    v_readlane_b32 s59, v162, 63
    v_readlane_b32 s60, v163, 63
    s_waitcnt vmcnt(4)
    v_lshlrev_b32 v120, 16, v125
    v_and_b32 v121, 0xffff0000, v125
    v_mul_f32 v162, s59, v166
    v_mul_f32 v165, s60, v166
    v_fma_f32 v165, -v162, v162, v165
    v_cvt_pk_bf16_f32 v162, 0, v162
    v_cvt_pk_bf16_f32 v165, 0, v165
    v_add_f32 v165, 0x3727c5ac, v165
    v_cvt_pk_bf16_f32 v165, 0, v165
    v_sqrt_f32 v163, v165
    s_nop 0
    v_cvt_pk_bf16_f32 v163, 0, v163
    v_rcp_f32 v164, v163
    v_sub_f32 v120, v120, v162
    v_cvt_pk_bf16_f32 v120, 0, v120
    v_mul_f32 v122, v120, v164
    v_fma_f32 v120, -v122, v163, v120
    v_fma_f32 v120, v120, v164, v122
    v_sub_f32 v121, v121, v162
    v_cvt_pk_bf16_f32 v121, 0, v121
    v_mul_f32 v123, v121, v164
    v_fma_f32 v121, -v123, v163, v121
    v_fma_f32 v121, v121, v164, v123
    v_cvt_pk_bf16_f32 v120, v120, v120
    v_cvt_pk_bf16_f32 v121, v121, v121
    v_and_b32 v12, v120, v2
    v_and_b32 v13, v120, v3
    v_and_b32 v14, v120, v4
    v_and_b32 v15, v120, v5
    v_and_b32 v124, v121, v2
    v_and_b32 v125, v121, v3
    v_and_b32 v126, v121, v4
    v_and_b32 v127, v121, v5
    s_waitcnt vmcnt(3)
    v_mfma_f32_16x16x32_bf16 v[8:11], v[12:15], v[112:115], 0
    s_waitcnt vmcnt(2)
    v_mfma_f32_16x16x32_bf16 v[8:11], v[124:127], v[116:119], v[8:11]
    s_waitcnt lgkmcnt(0)
    s_add_u32 s30, s30, 0x01010101
    s_and_b32 s31, s30, 0xff
    s_bfe_u32 s32, s30, 0x80008
    s_bfe_u32 s33, s30, 0x80010
    s_lshr_b32 s34, s30, 24
    s_mov_b64 exec, s[56:57]
    s_nop 0
    ds_write_b128 v7, v[8:11] offset:0
    s_mov_b64 exec, -1
    s_cmp_eq_u32 s3, 8
    s_cbranch_scc1 L_comm
    global_load_dwordx4 v[24:27], v6, s[44:45] offset:512 nt
    s_waitcnt lgkmcnt(0)
    s_barrier
    s_cmp_lt_u32 s38, 9
    s_cbranch_scc1 L_wo
    s_cmp_lt_u32 s38, 27
    s_cbranch_scc1 L_mlp
    s_cmp_eq_u32 s37, 12
    s_cbranch_scc1 L_idle_12
L_idle_11:
    v_and_b32 v161, 8, v1
    v_lshlrev_b32 v160, 5, v161
    v_and_b32 v163, 0xf0, v6
    v_lshrrev_b32 v164, 4, v1
    v_lshl_add_u32 v162, v164, 3, v160
    v_add_u32 v160, v160, v163
    v_xor_b32 v163, 0x100, v160
    s_lshl_b32 s59, s3, 5
    v_add_u32 v162, s59, v162
    v_mov_b32 v164, 0x3db504f3
    s_lshl_b32 s59, s3, 10
    v_lshl_add_u32 v161, v1, 4, s59
    s_waitcnt vmcnt(2)
    global_load_dwordx4 v[28:31], v6, s[44:45] offset:768 nt
    global_load_dwordx4 v[32:35], v6, s[44:45] offset:1024 nt
    s_waitcnt vmcnt(3)
    global_load_dwordx4 v[36:39], v6, s[44:45] offset:1280 nt
    s_waitcnt vmcnt(3)
    global_load_dwordx4 v[40:43], v6, s[44:45] offset:1536 nt
    s_waitcnt vmcnt(3)
    global_load_dwordx4 v[44:47], v6, s[44:45] offset:1792 nt
    s_waitcnt vmcnt(3)
    global_load_dwordx4 v[48:51], v6, s[44:45] offset:2048 nt
    s_waitcnt vmcnt(3)
    global_load_dwordx4 v[52:55], v6, s[44:45] offset:2304 nt
    s_waitcnt vmcnt(3)
    global_load_dwordx4 v[56:59], v6, s[44:45] offset:2560 nt
    s_waitcnt vmcnt(3)
    global_load_dwordx4 v[60:63], v6, s[46:47] offset:0 nt
    s_waitcnt vmcnt(3)
    global_load_dwordx4 v[64:67], v6, s[46:47] offset:256 nt
    s_waitcnt vmcnt(3)
    global_load_dwordx4 v[68:71], v6, s[46:47] offset:512 nt
    s_waitcnt vmcnt(3)
    global_load_dwordx4 v[72:75], v6, s[46:47] offset:768 nt
    global_load_dwordx4 v[76:79], v6, s[46:47] offset:1024 nt
    global_load_dwordx4 v[80:83], v6, s[46:47] offset:1280 nt
    global_load_dwordx4 v[84:87], v6, s[46:47] offset:1536 nt
    global_load_dwordx4 v[88:91], v6, s[46:47] offset:1792 nt
    s_barrier
    ds_read_b128 v[144:147], v160 offset:5888
    ds_read_b128 v[148:151], v163 offset:5888
    s_waitcnt lgkmcnt(0)
    v_dot2_f32_bf16 v152, v16, v144, 0
    v_dot2_f32_bf16 v12, v16, v148, 0
    v_dot2_f32_bf16 v152, v17, v145, v152
    v_dot2_f32_bf16 v12, v17, v149, v12
    v_dot2_f32_bf16 v152, v18, v146, v152
    v_dot2_f32_bf16 v12, v18, v150, v12
    v_dot2_f32_bf16 v152, v19, v147, v152
    v_dot2_f32_bf16 v12, v19, v151, v12
    v_dot2_f32_bf16 v153, v20, v144, 0
    v_dot2_f32_bf16 v13, v20, v148, 0
    v_dot2_f32_bf16 v153, v21, v145, v153
    v_add_f32_dpp v152, v12, v152 row_ror:8 row_mask:0xf bank_mask:0xf
    v_dot2_f32_bf16 v13, v21, v149, v13
    v_dot2_f32_bf16 v153, v22, v146, v153
    v_add_f32_dpp v152, v152, v152 quad_perm:[1,0,3,2] row_mask:0xf bank_mask:0xf
    v_dot2_f32_bf16 v13, v22, v150, v13
    v_dot2_f32_bf16 v153, v23, v147, v153
    v_add_f32_dpp v152, v152, v152 quad_perm:[2,3,0,1] row_mask:0xf bank_mask:0xf
    v_dot2_f32_bf16 v13, v23, v151, v13
    s_nop 0
    v_add_f32_dpp v152, v152, v152 row_half_mirror row_mask:0xf bank_mask:0xf
    v_cvt_pk_bf16_f32 v152, 0, v152
    v_mul_f32 v152, v152, v164
    v_cvt_pk_bf16_f32 v152, 0, v152
    v_add_f32_dpp v153, v13, v153 row_ror:8 row_mask:0xf bank_mask:0xf
    v_dot2_f32_bf16 v154, v24, v144, 0
    v_dot2_f32_bf16 v12, v24, v148, 0
    v_add_f32_dpp v153, v153, v153 quad_perm:[1,0,3,2] row_mask:0xf bank_mask:0xf
    v_dot2_f32_bf16 v154, v25, v145, v154
    v_dot2_f32_bf16 v12, v25, v149, v12
    v_add_f32_dpp v153, v153, v153 quad_perm:[2,3,0,1] row_mask:0xf bank_mask:0xf
    v_dot2_f32_bf16 v154, v26, v146, v154
    v_dot2_f32_bf16 v12, v26, v150, v12
    v_add_f32_dpp v153, v153, v153 row_half_mirror row_mask:0xf bank_mask:0xf
    v_cvt_pk_bf16_f32 v153, 0, v153
    v_mul_f32 v153, v153, v164
    v_cvt_pk_bf16_f32 v153, 0, v153
    v_dot2_f32_bf16 v154, v27, v147, v154
    v_dot2_f32_bf16 v12, v27, v151, v12
    v_dot2_f32_bf16 v155, v28, v144, 0
    v_dot2_f32_bf16 v13, v28, v148, 0
    v_dot2_f32_bf16 v155, v29, v145, v155
    v_add_f32_dpp v154, v12, v154 row_ror:8 row_mask:0xf bank_mask:0xf
    v_dot2_f32_bf16 v13, v29, v149, v13
    v_dot2_f32_bf16 v155, v30, v146, v155
    v_add_f32_dpp v154, v154, v154 quad_perm:[1,0,3,2] row_mask:0xf bank_mask:0xf
    v_dot2_f32_bf16 v13, v30, v150, v13
    v_dot2_f32_bf16 v155, v31, v147, v155
    v_add_f32_dpp v154, v154, v154 quad_perm:[2,3,0,1] row_mask:0xf bank_mask:0xf
    v_dot2_f32_bf16 v13, v31, v151, v13
    s_nop 0
    v_add_f32_dpp v154, v154, v154 row_half_mirror row_mask:0xf bank_mask:0xf
    v_cvt_pk_bf16_f32 v154, 0, v154
    v_mul_f32 v154, v154, v164
    v_cvt_pk_bf16_f32 v154, 0, v154
    v_add_f32_dpp v155, v13, v155 row_ror:8 row_mask:0xf bank_mask:0xf
    v_dot2_f32_bf16 v156, v32, v144, 0
    v_dot2_f32_bf16 v12, v32, v148, 0
    v_add_f32_dpp v155, v155, v155 quad_perm:[1,0,3,2] row_mask:0xf bank_mask:0xf
    v_dot2_f32_bf16 v156, v33, v145, v156
    v_dot2_f32_bf16 v12, v33, v149, v12
    v_add_f32_dpp v155, v155, v155 quad_perm:[2,3,0,1] row_mask:0xf bank_mask:0xf
    v_dot2_f32_bf16 v156, v34, v146, v156
    v_dot2_f32_bf16 v12, v34, v150, v12
    v_add_f32_dpp v155, v155, v155 row_half_mirror row_mask:0xf bank_mask:0xf
    v_cvt_pk_bf16_f32 v155, 0, v155
    v_mul_f32 v155, v155, v164
    v_cvt_pk_bf16_f32 v155, 0, v155
    v_dot2_f32_bf16 v156, v35, v147, v156
    v_dot2_f32_bf16 v12, v35, v151, v12
    v_dot2_f32_bf16 v157, v36, v144, 0
    v_dot2_f32_bf16 v13, v36, v148, 0
    v_dot2_f32_bf16 v157, v37, v145, v157
    v_add_f32_dpp v156, v12, v156 row_ror:8 row_mask:0xf bank_mask:0xf
    v_dot2_f32_bf16 v13, v37, v149, v13
    v_dot2_f32_bf16 v157, v38, v146, v157
    v_add_f32_dpp v156, v156, v156 quad_perm:[1,0,3,2] row_mask:0xf bank_mask:0xf
    v_dot2_f32_bf16 v13, v38, v150, v13
    v_dot2_f32_bf16 v157, v39, v147, v157
    v_add_f32_dpp v156, v156, v156 quad_perm:[2,3,0,1] row_mask:0xf bank_mask:0xf
    v_dot2_f32_bf16 v13, v39, v151, v13
    s_nop 0
    v_add_f32_dpp v156, v156, v156 row_half_mirror row_mask:0xf bank_mask:0xf
    v_cvt_pk_bf16_f32 v156, 0, v156
    v_mul_f32 v156, v156, v164
    v_cvt_pk_bf16_f32 v156, 0, v156
    v_add_f32_dpp v157, v13, v157 row_ror:8 row_mask:0xf bank_mask:0xf
    v_dot2_f32_bf16 v158, v40, v144, 0
    v_dot2_f32_bf16 v12, v40, v148, 0
    v_add_f32_dpp v157, v157, v157 quad_perm:[1,0,3,2] row_mask:0xf bank_mask:0xf
    v_dot2_f32_bf16 v158, v41, v145, v158
    v_dot2_f32_bf16 v12, v41, v149, v12
    v_add_f32_dpp v157, v157, v157 quad_perm:[2,3,0,1] row_mask:0xf bank_mask:0xf
    v_dot2_f32_bf16 v158, v42, v146, v158
    v_dot2_f32_bf16 v12, v42, v150, v12
    v_add_f32_dpp v157, v157, v157 row_half_mirror row_mask:0xf bank_mask:0xf
    v_cvt_pk_bf16_f32 v157, 0, v157
    v_mul_f32 v157, v157, v164
    v_cvt_pk_bf16_f32 v157, 0, v157
    v_dot2_f32_bf16 v158, v43, v147, v158
    v_dot2_f32_bf16 v12, v43, v151, v12
    v_dot2_f32_bf16 v159, v44, v144, 0
    v_dot2_f32_bf16 v13, v44, v148, 0
    v_dot2_f32_bf16 v159, v45, v145, v159
    v_add_f32_dpp v158, v12, v158 row_ror:8 row_mask:0xf bank_mask:0xf
    v_dot2_f32_bf16 v13, v45, v149, v13
    v_dot2_f32_bf16 v159, v46, v146, v159
    v_add_f32_dpp v158, v158, v158 quad_perm:[1,0,3,2] row_mask:0xf bank_mask:0xf
    v_dot2_f32_bf16 v13, v46, v150, v13
    v_dot2_f32_bf16 v159, v47, v147, v159
    v_add_f32_dpp v158, v158, v158 quad_perm:[2,3,0,1] row_mask:0xf bank_mask:0xf
    v_dot2_f32_bf16 v13, v47, v151, v13
    s_nop 0
    v_add_f32_dpp v158, v158, v158 row_half_mirror row_mask:0xf bank_mask:0xf
    v_cvt_pk_bf16_f32 v158, 0, v158
    v_mul_f32 v158, v158, v164
    v_cvt_pk_bf16_f32 v158, 0, v158
    v_add_f32_dpp v159, v13, v159 row_ror:8 row_mask:0xf bank_mask:0xf
    v_dot2_f32_bf16 v137, v48, v144, 0
    v_dot2_f32_bf16 v12, v48, v148, 0
    v_add_f32_dpp v159, v159, v159 quad_perm:[1,0,3,2] row_mask:0xf bank_mask:0xf
    v_dot2_f32_bf16 v137, v49, v145, v137
    v_dot2_f32_bf16 v12, v49, v149, v12
    v_add_f32_dpp v159, v159, v159 quad_perm:[2,3,0,1] row_mask:0xf bank_mask:0xf
    v_dot2_f32_bf16 v137, v50, v146, v137
    v_dot2_f32_bf16 v12, v50, v150, v12
    v_add_f32_dpp v159, v159, v159 row_half_mirror row_mask:0xf bank_mask:0xf
    v_cvt_pk_bf16_f32 v159, 0, v159
    v_mul_f32 v159, v159, v164
    v_cvt_pk_bf16_f32 v159, 0, v159
    v_dot2_f32_bf16 v137, v51, v147, v137
    v_dot2_f32_bf16 v12, v51, v151, v12
    v_dot2_f32_bf16 v138, v52, v144, 0
    v_dot2_f32_bf16 v13, v52, v148, 0
    v_dot2_f32_bf16 v138, v53, v145, v138
    v_add_f32_dpp v137, v12, v137 row_ror:8 row_mask:0xf bank_mask:0xf
    v_dot2_f32_bf16 v13, v53, v149, v13
    v_dot2_f32_bf16 v138, v54, v146, v138
    v_add_f32_dpp v137, v137, v137 quad_perm:[1,0,3,2] row_mask:0xf bank_mask:0xf
    v_dot2_f32_bf16 v13, v54, v150, v13
    v_dot2_f32_bf16 v138, v55, v147, v138
    v_add_f32_dpp v137, v137, v137 quad_perm:[2,3,0,1] row_mask:0xf bank_mask:0xf
    v_dot2_f32_bf16 v13, v55, v151, v13
    s_nop 0
    v_add_f32_dpp v137, v137, v137 row_half_mirror row_mask:0xf bank_mask:0xf
    v_cvt_pk_bf16_f32 v137, 0, v137
    v_mul_f32 v137, v137, v164
    v_cvt_pk_bf16_f32 v137, 0, v137
    v_add_f32_dpp v138, v13, v138 row_ror:8 row_mask:0xf bank_mask:0xf
    v_dot2_f32_bf16 v139, v56, v144, 0
    v_dot2_f32_bf16 v12, v56, v148, 0
    v_add_f32_dpp v138, v138, v138 quad_perm:[1,0,3,2] row_mask:0xf bank_mask:0xf
    v_dot2_f32_bf16 v139, v57, v145, v139
    v_dot2_f32_bf16 v12, v57, v149, v12
    v_add_f32_dpp v138, v138, v138 quad_perm:[2,3,0,1] row_mask:0xf bank_mask:0xf
    v_dot2_f32_bf16 v139, v58, v146, v139
    v_dot2_f32_bf16 v12, v58, v150, v12
    v_add_f32_dpp v138, v138, v138 row_half_mirror row_mask:0xf bank_mask:0xf
    v_cvt_pk_bf16_f32 v138, 0, v138
    v_mul_f32 v138, v138, v164
    v_cvt_pk_bf16_f32 v138, 0, v138
    v_dot2_f32_bf16 v139, v59, v147, v139
    v_dot2_f32_bf16 v12, v59, v151, v12
    v_max3_f32 v14, v152, v153, v154
    v_max3_f32 v14, v14, v155, v156
    v_max3_f32 v14, v14, v157, v158
    v_add_f32_dpp v139, v12, v139 row_ror:8 row_mask:0xf bank_mask:0xf
    v_max3_f32 v14, v14, v159, v137
    s_nop 0
    v_add_f32_dpp v139, v139, v139 quad_perm:[1,0,3,2] row_mask:0xf bank_mask:0xf
    s_nop 1
    v_add_f32_dpp v139, v139, v139 quad_perm:[2,3,0,1] row_mask:0xf bank_mask:0xf
    s_nop 1
    v_add_f32_dpp v139, v139, v139 row_half_mirror row_mask:0xf bank_mask:0xf
    v_cvt_pk_bf16_f32 v139, 0, v139
    v_mul_f32 v139, v139, v164
    v_cvt_pk_bf16_f32 v139, 0, v139
    v_max3_f32 v14, v14, v138, v139
    v_mov_b32 v12, v14
    s_nop 1
    v_permlane32_swap_b32 v12, v14
    v_max_f32 v14, v14, v12
    v_mov_b32 v12, v14
    s_nop 1
    v_permlane16_swap_b32 v12, v14
    v_max_f32 v14, v14, v12
    v_mul_f32 v12, s35, v14
    v_fma_f32 v152, v152, s35, -v12
    v_fma_f32 v153, v153, s35, -v12
    v_fma_f32 v154, v154, s35, -v12
    v_fma_f32 v155, v155, s35, -v12
    v_fma_f32 v156, v156, s35, -v12
    v_fma_f32 v157, v157, s35, -v12
    v_fma_f32 v158, v158, s35, -v12
    v_fma_f32 v159, v159, s35, -v12
    v_fma_f32 v137, v137, s35, -v12
    v_fma_f32 v138, v138, s35, -v12
    v_fma_f32 v139, v139, s35, -v12
    v_exp_f32 v152, v152
    v_exp_f32 v153, v153
    v_exp_f32 v154, v154
    v_exp_f32 v155, v155
    v_exp_f32 v156, v156
    v_exp_f32 v157, v157
    v_exp_f32 v158, v158
    v_exp_f32 v159, v159
    v_exp_f32 v137, v137
    v_exp_f32 v138, v138
    v_exp_f32 v139, v139
    v_add_f32 v12, v152, v153
    v_add_f32 v13, v154, v155
    v_add_f32 v15, v156, v157
    v_add_f32 v12, v12, v158
    v_add_f32 v13, v13, v159
    v_add_f32 v15, v15, v137
    v_add_f32 v12, v12, v138
    v_add_f32 v13, v13, v139
    v_add_f32 v15, v15, v12
    v_add_f32 v15, v15, v13
    s_mov_b64 exec, s[98:99]
    ds_write_b64 v162, v[14:15] offset:6400
    s_mov_b64 exec, -1
    v_cvt_pk_bf16_f32 v152, v152, v152
    v_cvt_pk_bf16_f32 v153, v153, v153
    v_cvt_pk_bf16_f32 v154, v154, v154
    v_cvt_pk_bf16_f32 v155, v155, v155
    v_cvt_pk_bf16_f32 v156, v156, v156
    v_cvt_pk_bf16_f32 v157, v157, v157
    v_cvt_pk_bf16_f32 v158, v158, v158
    v_cvt_pk_bf16_f32 v159, v159, v159
    v_cvt_pk_bf16_f32 v137, v137, v137
    v_cvt_pk_bf16_f32 v138, v138, v138
    v_cvt_pk_bf16_f32 v139, v139, v139
    v_and_b32 v16, v152, v2
    v_and_b32 v17, v152, v3
    v_and_b32 v18, v152, v4
    v_and_b32 v19, v152, v5
    v_and_b32 v20, v153, v2
    v_and_b32 v21, v153, v3
    v_and_b32 v22, v153, v4
    v_and_b32 v23, v153, v5
    v_and_b32 v24, v154, v2
    v_and_b32 v25, v154, v3
    v_and_b32 v26, v154, v4
    v_and_b32 v27, v154, v5
    v_and_b32 v28, v155, v2
    v_and_b32 v29, v155, v3
    v_and_b32 v30, v155, v4
    v_and_b32 v31, v155, v5
    v_and_b32 v32, v156, v2
    v_and_b32 v33, v156, v3
    v_and_b32 v34, v156, v4
    v_and_b32 v35, v156, v5
    v_and_b32 v36, v157, v2
    v_and_b32 v37, v157, v3
    v_and_b32 v38, v157, v4
    v_and_b32 v39, v157, v5
    v_and_b32 v40, v158, v2
    v_and_b32 v41, v158, v3
    v_and_b32 v42, v158, v4
    v_and_b32 v43, v158, v5
    v_and_b32 v44, v159, v2
    v_and_b32 v45, v159, v3
    v_and_b32 v46, v159, v4
    v_and_b32 v47, v159, v5
    v_and_b32 v48, v137, v2
    v_and_b32 v49, v137, v3
    v_and_b32 v50, v137, v4
    v_and_b32 v51, v137, v5
    v_and_b32 v52, v138, v2
    v_and_b32 v53, v138, v3
    v_and_b32 v54, v138, v4
    v_and_b32 v55, v138, v5
    v_and_b32 v56, v139, v2
    v_and_b32 v57, v139, v3
    v_and_b32 v58, v139, v4
    v_and_b32 v59, v139, v5
    global_load_dwordx4 v[92:95], v6, s[46:47] offset:2048 nt
    global_load_dwordx4 v[96:99], v6, s[46:47] offset:2304 nt
    global_load_dwordx4 v[100:103], v6, s[46:47] offset:2560 nt
    s_waitcnt vmcnt(10)
    v_mfma_f32_16x16x32_bf16 v[8:11], v[16:19], v[60:63], 0
    s_waitcnt vmcnt(9)
    v_mfma_f32_16x16x32_bf16 v[8:11], v[20:23], v[64:67], v[8:11]
    s_waitcnt vmcnt(8)
    v_mfma_f32_16x16x32_bf16 v[8:11], v[24:27], v[68:71], v[8:11]
    s_waitcnt vmcnt(7)
    v_mfma_f32_16x16x32_bf16 v[8:11], v[28:31], v[72:75], v[8:11]
    s_waitcnt vmcnt(6)
    v_mfma_f32_16x16x32_bf16 v[8:11], v[32:35], v[76:79], v[8:11]
    s_waitcnt vmcnt(5)
    v_mfma_f32_16x16x32_bf16 v[8:11], v[36:39], v[80:83], v[8:11]
    s_waitcnt vmcnt(4)
    v_mfma_f32_16x16x32_bf16 v[8:11], v[40:43], v[84:87], v[8:11]
    s_waitcnt vmcnt(3)
    v_mfma_f32_16x16x32_bf16 v[8:11], v[44:47], v[88:91], v[8:11]
    s_waitcnt vmcnt(2)
    v_mfma_f32_16x16x32_bf16 v[8:11], v[48:51], v[92:95], v[8:11]
    s_waitcnt vmcnt(1)
    v_mfma_f32_16x16x32_bf16 v[8:11], v[52:55], v[96:99], v[8:11]
    s_waitcnt vmcnt(0)
    v_mfma_f32_16x16x32_bf16 v[8:11], v[56:59], v[100:103], v[8:11]
    s_nop 7
    ds_write_b128 v161, v[8:11] offset:8192
    s_waitcnt lgkmcnt(0)
    s_barrier
    s_endpgm
L_idle_12:
    v_and_b32 v161, 8, v1
    v_lshlrev_b32 v160, 5, v161
    v_and_b32 v163, 0xf0, v6
    v_lshrrev_b32 v164, 4, v1
    v_lshl_add_u32 v162, v164, 3, v160
    v_add_u32 v160, v160, v163
    v_xor_b32 v163, 0x100, v160
    s_lshl_b32 s59, s3, 5
    v_add_u32 v162, s59, v162
    v_mov_b32 v164, 0x3db504f3
    s_lshl_b32 s59, s3, 10
    v_lshl_add_u32 v161, v1, 4, s59
    s_waitcnt vmcnt(2)
    global_load_dwordx4 v[28:31], v6, s[44:45] offset:768 nt
    global_load_dwordx4 v[32:35], v6, s[44:45] offset:1024 nt
    s_waitcnt vmcnt(3)
    global_load_dwordx4 v[36:39], v6, s[44:45] offset:1280 nt
    s_waitcnt vmcnt(3)
    global_load_dwordx4 v[40:43], v6, s[44:45] offset:1536 nt
    s_waitcnt vmcnt(3)
    global_load_dwordx4 v[44:47], v6, s[44:45] offset:1792 nt
    s_waitcnt vmcnt(3)
    global_load_dwordx4 v[48:51], v6, s[44:45] offset:2048 nt
    s_waitcnt vmcnt(3)
    global_load_dwordx4 v[52:55], v6, s[44:45] offset:2304 nt
    s_waitcnt vmcnt(3)
    global_load_dwordx4 v[56:59], v6, s[44:45] offset:2560 nt
    s_waitcnt vmcnt(3)
    global_load_dwordx4 v[60:63], v6, s[44:45] offset:2816 nt
    s_waitcnt vmcnt(3)
    global_load_dwordx4 v[64:67], v6, s[46:47] offset:0 nt
    s_waitcnt vmcnt(3)
    global_load_dwordx4 v[68:71], v6, s[46:47] offset:256 nt
    s_waitcnt vmcnt(3)
    global_load_dwordx4 v[72:75], v6, s[46:47] offset:512 nt
    s_waitcnt vmcnt(3)
    global_load_dwordx4 v[76:79], v6, s[46:47] offset:768 nt
    global_load_dwordx4 v[80:83], v6, s[46:47] offset:1024 nt
    global_load_dwordx4 v[84:87], v6, s[46:47] offset:1280 nt
    global_load_dwordx4 v[88:91], v6, s[46:47] offset:1536 nt
    global_load_dwordx4 v[92:95], v6, s[46:47] offset:1792 nt
    s_barrier
    ds_read_b128 v[144:147], v160 offset:5888
    ds_read_b128 v[148:151], v163 offset:5888
    s_waitcnt lgkmcnt(0)
    v_dot2_f32_bf16 v152, v16, v144, 0
    v_dot2_f32_bf16 v12, v16, v148, 0
    v_dot2_f32_bf16 v152, v17, v145, v152
    v_dot2_f32_bf16 v12, v17, v149, v12
    v_dot2_f32_bf16 v152, v18, v146, v152
    v_dot2_f32_bf16 v12, v18, v150, v12
    v_dot2_f32_bf16 v152, v19, v147, v152
    v_dot2_f32_bf16 v12, v19, v151, v12
    v_dot2_f32_bf16 v153, v20, v144, 0
    v_dot2_f32_bf16 v13, v20, v148, 0
    v_dot2_f32_bf16 v153, v21, v145, v153
    v_add_f32_dpp v152, v12, v152 row_ror:8 row_mask:0xf bank_mask:0xf
    v_dot2_f32_bf16 v13, v21, v149, v13
    v_dot2_f32_bf16 v153, v22, v146, v153
    v_add_f32_dpp v152, v152, v152 quad_perm:[1,0,3,2] row_mask:0xf bank_mask:0xf
    v_dot2_f32_bf16 v13, v22, v150, v13
    v_dot2_f32_bf16 v153, v23, v147, v153
    v_add_f32_dpp v152, v152, v152 quad_perm:[2,3,0,1] row_mask:0xf bank_mask:0xf
    v_dot2_f32_bf16 v13, v23, v151, v13
    s_nop 0
    v_add_f32_dpp v152, v152, v152 row_half_mirror row_mask:0xf bank_mask:0xf
    v_cvt_pk_bf16_f32 v152, 0, v152
    v_mul_f32 v152, v152, v164
    v_cvt_pk_bf16_f32 v152, 0, v152
    v_add_f32_dpp v153, v13, v153 row_ror:8 row_mask:0xf bank_mask:0xf
    v_dot2_f32_bf16 v154, v24, v144, 0
    v_dot2_f32_bf16 v12, v24, v148, 0
    v_add_f32_dpp v153, v153, v153 quad_perm:[1,0,3,2] row_mask:0xf bank_mask:0xf
    v_dot2_f32_bf16 v154, v25, v145, v154
    v_dot2_f32_bf16 v12, v25, v149, v12
    v_add_f32_dpp v153, v153, v153 quad_perm:[2,3,0,1] row_mask:0xf bank_mask:0xf
    v_dot2_f32_bf16 v154, v26, v146, v154
    v_dot2_f32_bf16 v12, v26, v150, v12
    v_add_f32_dpp v153, v153, v153 row_half_mirror row_mask:0xf bank_mask:0xf
    v_cvt_pk_bf16_f32 v153, 0, v153
    v_mul_f32 v153, v153, v164
    v_cvt_pk_bf16_f32 v153, 0, v153
    v_dot2_f32_bf16 v154, v27, v147, v154
    v_dot2_f32_bf16 v12, v27, v151, v12
    v_dot2_f32_bf16 v155, v28, v144, 0
    v_dot2_f32_bf16 v13, v28, v148, 0
    v_dot2_f32_bf16 v155, v29, v145, v155
    v_add_f32_dpp v154, v12, v154 row_ror:8 row_mask:0xf bank_mask:0xf
    v_dot2_f32_bf16 v13, v29, v149, v13
    v_dot2_f32_bf16 v155, v30, v146, v155
    v_add_f32_dpp v154, v154, v154 quad_perm:[1,0,3,2] row_mask:0xf bank_mask:0xf
    v_dot2_f32_bf16 v13, v30, v150, v13
    v_dot2_f32_bf16 v155, v31, v147, v155
    v_add_f32_dpp v154, v154, v154 quad_perm:[2,3,0,1] row_mask:0xf bank_mask:0xf
    v_dot2_f32_bf16 v13, v31, v151, v13
    s_nop 0
    v_add_f32_dpp v154, v154, v154 row_half_mirror row_mask:0xf bank_mask:0xf
    v_cvt_pk_bf16_f32 v154, 0, v154
    v_mul_f32 v154, v154, v164
    v_cvt_pk_bf16_f32 v154, 0, v154
    v_add_f32_dpp v155, v13, v155 row_ror:8 row_mask:0xf bank_mask:0xf
    v_dot2_f32_bf16 v156, v32, v144, 0
    v_dot2_f32_bf16 v12, v32, v148, 0
    v_add_f32_dpp v155, v155, v155 quad_perm:[1,0,3,2] row_mask:0xf bank_mask:0xf
    v_dot2_f32_bf16 v156, v33, v145, v156
    v_dot2_f32_bf16 v12, v33, v149, v12
    v_add_f32_dpp v155, v155, v155 quad_perm:[2,3,0,1] row_mask:0xf bank_mask:0xf
    v_dot2_f32_bf16 v156, v34, v146, v156
    v_dot2_f32_bf16 v12, v34, v150, v12
    v_add_f32_dpp v155, v155, v155 row_half_mirror row_mask:0xf bank_mask:0xf
    v_cvt_pk_bf16_f32 v155, 0, v155
    v_mul_f32 v155, v155, v164
    v_cvt_pk_bf16_f32 v155, 0, v155
    v_dot2_f32_bf16 v156, v35, v147, v156
    v_dot2_f32_bf16 v12, v35, v151, v12
    v_dot2_f32_bf16 v157, v36, v144, 0
    v_dot2_f32_bf16 v13, v36, v148, 0
    v_dot2_f32_bf16 v157, v37, v145, v157
    v_add_f32_dpp v156, v12, v156 row_ror:8 row_mask:0xf bank_mask:0xf
    v_dot2_f32_bf16 v13, v37, v149, v13
    v_dot2_f32_bf16 v157, v38, v146, v157
    v_add_f32_dpp v156, v156, v156 quad_perm:[1,0,3,2] row_mask:0xf bank_mask:0xf
    v_dot2_f32_bf16 v13, v38, v150, v13
    v_dot2_f32_bf16 v157, v39, v147, v157
    v_add_f32_dpp v156, v156, v156 quad_perm:[2,3,0,1] row_mask:0xf bank_mask:0xf
    v_dot2_f32_bf16 v13, v39, v151, v13
    s_nop 0
    v_add_f32_dpp v156, v156, v156 row_half_mirror row_mask:0xf bank_mask:0xf
    v_cvt_pk_bf16_f32 v156, 0, v156
    v_mul_f32 v156, v156, v164
    v_cvt_pk_bf16_f32 v156, 0, v156
    v_add_f32_dpp v157, v13, v157 row_ror:8 row_mask:0xf bank_mask:0xf
    v_dot2_f32_bf16 v158, v40, v144, 0
    v_dot2_f32_bf16 v12, v40, v148, 0
    v_add_f32_dpp v157, v157, v157 quad_perm:[1,0,3,2] row_mask:0xf bank_mask:0xf
    v_dot2_f32_bf16 v158, v41, v145, v158
    v_dot2_f32_bf16 v12, v41, v149, v12
    v_add_f32_dpp v157, v157, v157 quad_perm:[2,3,0,1] row_mask:0xf bank_mask:0xf
    v_dot2_f32_bf16 v158, v42, v146, v158
    v_dot2_f32_bf16 v12, v42, v150, v12
    v_add_f32_dpp v157, v157, v157 row_half_mirror row_mask:0xf bank_mask:0xf
    v_cvt_pk_bf16_f32 v157, 0, v157
    v_mul_f32 v157, v157, v164
    v_cvt_pk_bf16_f32 v157, 0, v157
    v_dot2_f32_bf16 v158, v43, v147, v158
    v_dot2_f32_bf16 v12, v43, v151, v12
    v_dot2_f32_bf16 v159, v44, v144, 0
    v_dot2_f32_bf16 v13, v44, v148, 0
    v_dot2_f32_bf16 v159, v45, v145, v159
    v_add_f32_dpp v158, v12, v158 row_ror:8 row_mask:0xf bank_mask:0xf
    v_dot2_f32_bf16 v13, v45, v149, v13
    v_dot2_f32_bf16 v159, v46, v146, v159
    v_add_f32_dpp v158, v158, v158 quad_perm:[1,0,3,2] row_mask:0xf bank_mask:0xf
    v_dot2_f32_bf16 v13, v46, v150, v13
    v_dot2_f32_bf16 v159, v47, v147, v159
    v_add_f32_dpp v158, v158, v158 quad_perm:[2,3,0,1] row_mask:0xf bank_mask:0xf
    v_dot2_f32_bf16 v13, v47, v151, v13
    s_nop 0
    v_add_f32_dpp v158, v158, v158 row_half_mirror row_mask:0xf bank_mask:0xf
    v_cvt_pk_bf16_f32 v158, 0, v158
    v_mul_f32 v158, v158, v164
    v_cvt_pk_bf16_f32 v158, 0, v158
    v_add_f32_dpp v159, v13, v159 row_ror:8 row_mask:0xf bank_mask:0xf
    v_dot2_f32_bf16 v137, v48, v144, 0
    v_dot2_f32_bf16 v12, v48, v148, 0
    v_add_f32_dpp v159, v159, v159 quad_perm:[1,0,3,2] row_mask:0xf bank_mask:0xf
    v_dot2_f32_bf16 v137, v49, v145, v137
    v_dot2_f32_bf16 v12, v49, v149, v12
    v_add_f32_dpp v159, v159, v159 quad_perm:[2,3,0,1] row_mask:0xf bank_mask:0xf
    v_dot2_f32_bf16 v137, v50, v146, v137
    v_dot2_f32_bf16 v12, v50, v150, v12
    v_add_f32_dpp v159, v159, v159 row_half_mirror row_mask:0xf bank_mask:0xf
    v_cvt_pk_bf16_f32 v159, 0, v159
    v_mul_f32 v159, v159, v164
    v_cvt_pk_bf16_f32 v159, 0, v159
    v_dot2_f32_bf16 v137, v51, v147, v137
    v_dot2_f32_bf16 v12, v51, v151, v12
    v_dot2_f32_bf16 v138, v52, v144, 0
    v_dot2_f32_bf16 v13, v52, v148, 0
    v_dot2_f32_bf16 v138, v53, v145, v138
    v_add_f32_dpp v137, v12, v137 row_ror:8 row_mask:0xf bank_mask:0xf
    v_dot2_f32_bf16 v13, v53, v149, v13
    v_dot2_f32_bf16 v138, v54, v146, v138
    v_add_f32_dpp v137, v137, v137 quad_perm:[1,0,3,2] row_mask:0xf bank_mask:0xf
    v_dot2_f32_bf16 v13, v54, v150, v13
    v_dot2_f32_bf16 v138, v55, v147, v138
    v_add_f32_dpp v137, v137, v137 quad_perm:[2,3,0,1] row_mask:0xf bank_mask:0xf
    v_dot2_f32_bf16 v13, v55, v151, v13
    s_nop 0
    v_add_f32_dpp v137, v137, v137 row_half_mirror row_mask:0xf bank_mask:0xf
    v_cvt_pk_bf16_f32 v137, 0, v137
    v_mul_f32 v137, v137, v164
    v_cvt_pk_bf16_f32 v137, 0, v137
    v_add_f32_dpp v138, v13, v138 row_ror:8 row_mask:0xf bank_mask:0xf
    v_dot2_f32_bf16 v139, v56, v144, 0
    v_dot2_f32_bf16 v12, v56, v148, 0
    v_add_f32_dpp v138, v138, v138 quad_perm:[1,0,3,2] row_mask:0xf bank_mask:0xf
    v_dot2_f32_bf16 v139, v57, v145, v139
    v_dot2_f32_bf16 v12, v57, v149, v12
    v_add_f32_dpp v138, v138, v138 quad_perm:[2,3,0,1] row_mask:0xf bank_mask:0xf
    v_dot2_f32_bf16 v139, v58, v146, v139
    v_dot2_f32_bf16 v12, v58, v150, v12
    v_add_f32_dpp v138, v138, v138 row_half_mirror row_mask:0xf bank_mask:0xf
    v_cvt_pk_bf16_f32 v138, 0, v138
    v_mul_f32 v138, v138, v164
    v_cvt_pk_bf16_f32 v138, 0, v138
    v_dot2_f32_bf16 v139, v59, v147, v139
    v_dot2_f32_bf16 v12, v59, v151, v12
    v_dot2_f32_bf16 v140, v60, v144, 0
    v_dot2_f32_bf16 v13, v60, v148, 0
    v_dot2_f32_bf16 v140, v61, v145, v140
    v_add_f32_dpp v139, v12, v139 row_ror:8 row_mask:0xf bank_mask:0xf
    v_dot2_f32_bf16 v13, v61, v149, v13
    v_dot2_f32_bf16 v140, v62, v146, v140
    v_add_f32_dpp v139, v139, v139 quad_perm:[1,0,3,2] row_mask:0xf bank_mask:0xf
    v_dot2_f32_bf16 v13, v62, v150, v13
    v_dot2_f32_bf16 v140, v63, v147, v140
    v_add_f32_dpp v139, v139, v139 quad_perm:[2,3,0,1] row_mask:0xf bank_mask:0xf
    v_dot2_f32_bf16 v13, v63, v151, v13
    s_nop 0
    v_add_f32_dpp v139, v139, v139 row_half_mirror row_mask:0xf bank_mask:0xf
    v_cvt_pk_bf16_f32 v139, 0, v139
    v_mul_f32 v139, v139, v164
    v_cvt_pk_bf16_f32 v139, 0, v139
    v_add_f32_dpp v140, v13, v140 row_ror:8 row_mask:0xf bank_mask:0xf
    v_max3_f32 v14, v152, v153, v154
    v_max3_f32 v14, v14, v155, v156
    v_add_f32_dpp v140, v140, v140 quad_perm:[1,0,3,2] row_mask:0xf bank_mask:0xf
    v_max3_f32 v14, v14, v157, v158
    v_max3_f32 v14, v14, v159, v137
    v_add_f32_dpp v140, v140, v140 quad_perm:[2,3,0,1] row_mask:0xf bank_mask:0xf
    v_max3_f32 v14, v14, v138, v139
    s_nop 0
    v_add_f32_dpp v140, v140, v140 row_half_mirror row_mask:0xf bank_mask:0xf
    v_cvt_pk_bf16_f32 v140, 0, v140
    v_mul_f32 v140, v140, v164
    v_cvt_pk_bf16_f32 v140, 0, v140
    v_max_f32 v14, v14, v140
    v_mov_b32 v12, v14
    s_nop 1
    v_permlane32_swap_b32 v12, v14
    v_max_f32 v14, v14, v12
    v_mov_b32 v12, v14
    s_nop 1
    v_permlane16_swap_b32 v12, v14
    v_max_f32 v14, v14, v12
    v_mul_f32 v12, s35, v14
    v_fma_f32 v152, v152, s35, -v12
    v_fma_f32 v153, v153, s35, -v12
    v_fma_f32 v154, v154, s35, -v12
    v_fma_f32 v155, v155, s35, -v12
    v_fma_f32 v156, v156, s35, -v12
    v_fma_f32 v157, v157, s35, -v12
    v_fma_f32 v158, v158, s35, -v12
    v_fma_f32 v159, v159, s35, -v12
    v_fma_f32 v137, v137, s35, -v12
    v_fma_f32 v138, v138, s35, -v12
    v_fma_f32 v139, v139, s35, -v12
    v_fma_f32 v140, v140, s35, -v12
    v_exp_f32 v152, v152
    v_exp_f32 v153, v153
    v_exp_f32 v154, v154
    v_exp_f32 v155, v155
    v_exp_f32 v156, v156
    v_exp_f32 v157, v157
    v_exp_f32 v158, v158
    v_exp_f32 v159, v159
    v_exp_f32 v137, v137
    v_exp_f32 v138, v138
    v_exp_f32 v139, v139
    v_exp_f32 v140, v140
    v_add_f32 v12, v152, v153
    v_add_f32 v13, v154, v155
    v_add_f32 v15, v156, v157
    v_add_f32 v12, v12, v158
    v_add_f32 v13, v13, v159
    v_add_f32 v15, v15, v137
    v_add_f32 v12, v12, v138
    v_add_f32 v13, v13, v139
    v_add_f32 v15, v15, v140
    v_add_f32 v15, v15, v12
    v_add_f32 v15, v15, v13
    s_mov_b64 exec, s[98:99]
    ds_write_b64 v162, v[14:15] offset:6400
    s_mov_b64 exec, -1
    v_cvt_pk_bf16_f32 v152, v152, v152
    v_cvt_pk_bf16_f32 v153, v153, v153
    v_cvt_pk_bf16_f32 v154, v154, v154
    v_cvt_pk_bf16_f32 v155, v155, v155
    v_cvt_pk_bf16_f32 v156, v156, v156
    v_cvt_pk_bf16_f32 v157, v157, v157
    v_cvt_pk_bf16_f32 v158, v158, v158
    v_cvt_pk_bf16_f32 v159, v159, v159
    v_cvt_pk_bf16_f32 v137, v137, v137
    v_cvt_pk_bf16_f32 v138, v138, v138
    v_cvt_pk_bf16_f32 v139, v139, v139
    v_cvt_pk_bf16_f32 v140, v140, v140
    v_and_b32 v16, v152, v2
    v_and_b32 v17, v152, v3
    v_and_b32 v18, v152, v4
    v_and_b32 v19, v152, v5
    v_and_b32 v20, v153, v2
    v_and_b32 v21, v153, v3
    v_and_b32 v22, v153, v4
    v_and_b32 v23, v153, v5
    v_and_b32 v24, v154, v2
    v_and_b32 v25, v154, v3
    v_and_b32 v26, v154, v4
    v_and_b32 v27, v154, v5
    v_and_b32 v28, v155, v2
    v_and_b32 v29, v155, v3
    v_and_b32 v30, v155, v4
    v_and_b32 v31, v155, v5
    v_and_b32 v32, v156, v2
    v_and_b32 v33, v156, v3
    v_and_b32 v34, v156, v4
    v_and_b32 v35, v156, v5
    v_and_b32 v36, v157, v2
    v_and_b32 v37, v157, v3
    v_and_b32 v38, v157, v4
    v_and_b32 v39, v157, v5
    v_and_b32 v40, v158, v2
    v_and_b32 v41, v158, v3
    v_and_b32 v42, v158, v4
    v_and_b32 v43, v158, v5
    v_and_b32 v44, v159, v2
    v_and_b32 v45, v159, v3
    v_and_b32 v46, v159, v4
    v_and_b32 v47, v159, v5
    v_and_b32 v48, v137, v2
    v_and_b32 v49, v137, v3
    v_and_b32 v50, v137, v4
    v_and_b32 v51, v137, v5
    v_and_b32 v52, v138, v2
    v_and_b32 v53, v138, v3
    v_and_b32 v54, v138, v4
    v_and_b32 v55, v138, v5
    v_and_b32 v56, v139, v2
    v_and_b32 v57, v139, v3
    v_and_b32 v58, v139, v4
    v_and_b32 v59, v139, v5
    v_and_b32 v60, v140, v2
    v_and_b32 v61, v140, v3
    v_and_b32 v62, v140, v4
    v_and_b32 v63, v140, v5
    global_load_dwordx4 v[96:99], v6, s[46:47] offset:2048 nt
    global_load_dwordx4 v[100:103], v6, s[46:47] offset:2304 nt
    global_load_dwordx4 v[104:107], v6, s[46:47] offset:2560 nt
    global_load_dwordx4 v[108:111], v6, s[46:47] offset:2816 nt
    s_waitcnt vmcnt(11)
    v_mfma_f32_16x16x32_bf16 v[8:11], v[16:19], v[64:67], 0
    s_waitcnt vmcnt(10)
    v_mfma_f32_16x16x32_bf16 v[8:11], v[20:23], v[68:71], v[8:11]
    s_waitcnt vmcnt(9)
    v_mfma_f32_16x16x32_bf16 v[8:11], v[24:27], v[72:75], v[8:11]
    s_waitcnt vmcnt(8)
    v_mfma_f32_16x16x32_bf16 v[8:11], v[28:31], v[76:79], v[8:11]
    s_waitcnt vmcnt(7)
    v_mfma_f32_16x16x32_bf16 v[8:11], v[32:35], v[80:83], v[8:11]
    s_waitcnt vmcnt(6)
    v_mfma_f32_16x16x32_bf16 v[8:11], v[36:39], v[84:87], v[8:11]
    s_waitcnt vmcnt(5)
    v_mfma_f32_16x16x32_bf16 v[8:11], v[40:43], v[88:91], v[8:11]
    s_waitcnt vmcnt(4)
    v_mfma_f32_16x16x32_bf16 v[8:11], v[44:47], v[92:95], v[8:11]
    s_waitcnt vmcnt(3)
    v_mfma_f32_16x16x32_bf16 v[8:11], v[48:51], v[96:99], v[8:11]
    s_waitcnt vmcnt(2)
    v_mfma_f32_16x16x32_bf16 v[8:11], v[52:55], v[100:103], v[8:11]
    s_waitcnt vmcnt(1)
    v_mfma_f32_16x16x32_bf16 v[8:11], v[56:59], v[104:107], v[8:11]
    s_waitcnt vmcnt(0)
    v_mfma_f32_16x16x32_bf16 v[8:11], v[60:63], v[108:111], v[8:11]
    s_nop 7
    ds_write_b128 v161, v[8:11] offset:8192
    s_waitcnt lgkmcnt(0)
    s_barrier
    s_endpgm
L_mlp:
    s_max_u32 s59, s38, 9
    s_sub_u32 s59, s59, 9
    s_min_u32 s59, s59, 17
    s_lshr_b32 s60, s59, 1
    s_lshl3_add_u32 s61, s42, s60
    s_add_u32 s43, s42, 64
    s_cmp_lt_u32 s60, 8
    s_cselect_b32 s61, s61, s43
    s_and_b32 s59, s59, 1
    s_lshl1_add_u32 s43, s61, s59
    v_lshrrev_b32 v122, 3, v1
    v_and_b32 v123, 0x70, v6
    v_and_b32 v124, 3, v1
    v_and_b32 v120, 0x30, v1
    v_bfe_u32 v125, v1, 2, 1
    v_lshl_add_u32 v120, v125, 1, v120
    v_and_b32 v121, 1, v122
    v_add_u32 v120, v120, v121
    v_mov_b32 v121, 9216
    v_lshlrev_b32 v124, 4, v124
    v_mad_u32_u24 v120, v120, v121, v124
    v_mov_b32 v121, 4608
    v_mad_u32_u24 v121, v122, v121, v123
    s_mul_i32 s59, s3, 589824
    s_lshl_b32 s60, s43, 6
    s_add_u32 s59, s59, s60
    s_add_u32 s52, s16, s59
    s_addc_u32 s53, s17, 0
    s_mul_i32 s59, s43, 36864
    s_lshl_b32 s60, s3, 7
    s_add_u32 s59, s59, s60
    s_add_u32 s54, s20, s59
    s_addc_u32 s55, s21, 0
    s_cmp_eq_u32 s37, 9
    s_cbranch_scc1 L_mlp_9
L_mlp_7:
    v_and_b32 v161, 8, v1
    v_lshlrev_b32 v160, 5, v161
    v_and_b32 v163, 0xf0, v6
    v_lshrrev_b32 v164, 4, v1
    v_lshl_add_u32 v162, v164, 3, v160
    v_add_u32 v160, v160, v163
    v_xor_b32 v163, 0x100, v160
    s_lshl_b32 s59, s3, 5
    v_add_u32 v162, s59, v162
    v_mov_b32 v164, 0x3db504f3
    s_lshl_b32 s59, s3, 10
    v_lshl_add_u32 v161, v1, 4, s59
    s_waitcnt vmcnt(2)
    global_load_dwordx4 v[28:31], v6, s[44:45] offset:768 nt
    s_waitcnt vmcnt(2)
    global_load_dwordx4 v[32:35], v6, s[44:45] offset:1024 nt
    s_waitcnt vmcnt(2)
    global_load_dwordx4 v[36:39], v6, s[44:45] offset:1280 nt
    s_waitcnt vmcnt(2)
    global_load_dwordx4 v[40:43], v6, s[44:45] offset:1536 nt
    s_waitcnt vmcnt(2)
    global_load_dwordx4 v[44:47], v6, s[46:47] offset:0 nt
    s_waitcnt vmcnt(2)
    global_load_dwordx4 v[48:51], v6, s[46:47] offset:256 nt
    s_waitcnt vmcnt(2)
    global_load_dwordx4 v[52:55], v6, s[46:47] offset:512 nt
    global_load_dwordx4 v[56:59], v6, s[46:47] offset:768 nt
    global_load_dwordx4 v[60:63], v6, s[46:47] offset:1024 nt
    global_load_dwordx4 v[64:67], v6, s[46:47] offset:1280 nt
    s_barrier
    ds_read_b128 v[144:147], v160 offset:5888
    ds_read_b128 v[148:151], v163 offset:5888
    global_load_dwordx4 v[68:71], v6, s[46:47] offset:1536 nt
    s_waitcnt lgkmcnt(0)
    v_dot2_f32_bf16 v152, v16, v144, 0
    v_dot2_f32_bf16 v12, v16, v148, 0
    v_dot2_f32_bf16 v152, v17, v145, v152
    v_dot2_f32_bf16 v12, v17, v149, v12
    v_dot2_f32_bf16 v152, v18, v146, v152
    v_dot2_f32_bf16 v12, v18, v150, v12
    v_dot2_f32_bf16 v152, v19, v147, v152
    v_dot2_f32_bf16 v12, v19, v151, v12
    v_dot2_f32_bf16 v153, v20, v144, 0
    v_dot2_f32_bf16 v13, v20, v148, 0
    v_dot2_f32_bf16 v153, v21, v145, v153
    v_add_f32_dpp v152, v12, v152 row_ror:8 row_mask:0xf bank_mask:0xf
    v_dot2_f32_bf16 v13, v21, v149, v13
    v_dot2_f32_bf16 v153, v22, v146, v153
    v_add_f32_dpp v152, v152, v152 quad_perm:[1,0,3,2] row_mask:0xf bank_mask:0xf
    v_dot2_f32_bf16 v13, v22, v150, v13
    v_dot2_f32_bf16 v153, v23, v147, v153
    v_add_f32_dpp v152, v152, v152 quad_perm:[2,3,0,1] row_mask:0xf bank_mask:0xf
    v_dot2_f32_bf16 v13, v23, v151, v13
    s_nop 0
    v_add_f32_dpp v152, v152, v152 row_half_mirror row_mask:0xf bank_mask:0xf
    v_cvt_pk_bf16_f32 v152, 0, v152
    v_mul_f32 v152, v152, v164
    v_cvt_pk_bf16_f32 v152, 0, v152
    v_add_f32_dpp v153, v13, v153 row_ror:8 row_mask:0xf bank_mask:0xf
    v_dot2_f32_bf16 v154, v24, v144, 0
    v_dot2_f32_bf16 v12, v24, v148, 0
    v_add_f32_dpp v153, v153, v153 quad_perm:[1,0,3,2] row_mask:0xf bank_mask:0xf
    v_dot2_f32_bf16 v154, v25, v145, v154
    v_dot2_f32_bf16 v12, v25, v149, v12
    v_add_f32_dpp v153, v153, v153 quad_perm:[2,3,0,1] row_mask:0xf bank_mask:0xf
    v_dot2_f32_bf16 v154, v26, v146, v154
    v_dot2_f32_bf16 v12, v26, v150, v12
    v_add_f32_dpp v153, v153, v153 row_half_mirror row_mask:0xf bank_mask:0xf
    v_cvt_pk_bf16_f32 v153, 0, v153
    v_mul_f32 v153, v153, v164
    v_cvt_pk_bf16_f32 v153, 0, v153
    v_dot2_f32_bf16 v154, v27, v147, v154
    v_dot2_f32_bf16 v12, v27, v151, v12
    v_dot2_f32_bf16 v155, v28, v144, 0
    v_dot2_f32_bf16 v13, v28, v148, 0
    v_dot2_f32_bf16 v155, v29, v145, v155
    v_add_f32_dpp v154, v12, v154 row_ror:8 row_mask:0xf bank_mask:0xf
    v_dot2_f32_bf16 v13, v29, v149, v13
    v_dot2_f32_bf16 v155, v30, v146, v155
    v_add_f32_dpp v154, v154, v154 quad_perm:[1,0,3,2] row_mask:0xf bank_mask:0xf
    v_dot2_f32_bf16 v13, v30, v150, v13
    v_dot2_f32_bf16 v155, v31, v147, v155
    v_add_f32_dpp v154, v154, v154 quad_perm:[2,3,0,1] row_mask:0xf bank_mask:0xf
    v_dot2_f32_bf16 v13, v31, v151, v13
    s_nop 0
    v_add_f32_dpp v154, v154, v154 row_half_mirror row_mask:0xf bank_mask:0xf
    v_cvt_pk_bf16_f32 v154, 0, v154
    v_mul_f32 v154, v154, v164
    v_cvt_pk_bf16_f32 v154, 0, v154
    v_add_f32_dpp v155, v13, v155 row_ror:8 row_mask:0xf bank_mask:0xf
    v_dot2_f32_bf16 v156, v32, v144, 0
    v_dot2_f32_bf16 v12, v32, v148, 0
    v_add_f32_dpp v155, v155, v155 quad_perm:[1,0,3,2] row_mask:0xf bank_mask:0xf
    v_dot2_f32_bf16 v156, v33, v145, v156
    v_dot2_f32_bf16 v12, v33, v149, v12
    v_add_f32_dpp v155, v155, v155 quad_perm:[2,3,0,1] row_mask:0xf bank_mask:0xf
    v_dot2_f32_bf16 v156, v34, v146, v156
    v_dot2_f32_bf16 v12, v34, v150, v12
    v_add_f32_dpp v155, v155, v155 row_half_mirror row_mask:0xf bank_mask:0xf
    v_cvt_pk_bf16_f32 v155, 0, v155
    v_mul_f32 v155, v155, v164
    v_cvt_pk_bf16_f32 v155, 0, v155
    v_dot2_f32_bf16 v156, v35, v147, v156
    v_dot2_f32_bf16 v12, v35, v151, v12
    v_dot2_f32_bf16 v157, v36, v144, 0
    v_dot2_f32_bf16 v13, v36, v148, 0
    v_dot2_f32_bf16 v157, v37, v145, v157
    v_add_f32_dpp v156, v12, v156 row_ror:8 row_mask:0xf bank_mask:0xf
    v_dot2_f32_bf16 v13, v37, v149, v13
    v_dot2_f32_bf16 v157, v38, v146, v157
    v_add_f32_dpp v156, v156, v156 quad_perm:[1,0,3,2] row_mask:0xf bank_mask:0xf
    v_dot2_f32_bf16 v13, v38, v150, v13
    v_dot2_f32_bf16 v157, v39, v147, v157
    v_add_f32_dpp v156, v156, v156 quad_perm:[2,3,0,1] row_mask:0xf bank_mask:0xf
    v_dot2_f32_bf16 v13, v39, v151, v13
    s_nop 0
    v_add_f32_dpp v156, v156, v156 row_half_mirror row_mask:0xf bank_mask:0xf
    v_cvt_pk_bf16_f32 v156, 0, v156
    v_mul_f32 v156, v156, v164
    v_cvt_pk_bf16_f32 v156, 0, v156
    v_add_f32_dpp v157, v13, v157 row_ror:8 row_mask:0xf bank_mask:0xf
    v_dot2_f32_bf16 v158, v40, v144, 0
    v_dot2_f32_bf16 v12, v40, v148, 0
    v_add_f32_dpp v157, v157, v157 quad_perm:[1,0,3,2] row_mask:0xf bank_mask:0xf
    v_dot2_f32_bf16 v158, v41, v145, v158
    v_dot2_f32_bf16 v12, v41, v149, v12
    v_add_f32_dpp v157, v157, v157 quad_perm:[2,3,0,1] row_mask:0xf bank_mask:0xf
    v_dot2_f32_bf16 v158, v42, v146, v158
    v_dot2_f32_bf16 v12, v42, v150, v12
    v_add_f32_dpp v157, v157, v157 row_half_mirror row_mask:0xf bank_mask:0xf
    v_cvt_pk_bf16_f32 v157, 0, v157
    v_mul_f32 v157, v157, v164
    v_cvt_pk_bf16_f32 v157, 0, v157
    v_dot2_f32_bf16 v158, v43, v147, v158
    v_dot2_f32_bf16 v12, v43, v151, v12
    v_max3_f32 v14, v152, v153, v154
    v_max3_f32 v14, v14, v155, v156
    s_nop 0
    v_add_f32_dpp v158, v12, v158 row_ror:8 row_mask:0xf bank_mask:0xf
    s_nop 1
    v_add_f32_dpp v158, v158, v158 quad_perm:[1,0,3,2] row_mask:0xf bank_mask:0xf
    s_nop 1
    v_add_f32_dpp v158, v158, v158 quad_perm:[2,3,0,1] row_mask:0xf bank_mask:0xf
    s_nop 1
    v_add_f32_dpp v158, v158, v158 row_half_mirror row_mask:0xf bank_mask:0xf
    v_cvt_pk_bf16_f32 v158, 0, v158
    v_mul_f32 v158, v158, v164
    v_cvt_pk_bf16_f32 v158, 0, v158
    v_max3_f32 v14, v14, v157, v158
    v_mov_b32 v12, v14
    s_nop 1
    v_permlane32_swap_b32 v12, v14
    v_max_f32 v14, v14, v12
    v_mov_b32 v12, v14
    s_nop 1
    v_permlane16_swap_b32 v12, v14
    v_max_f32 v14, v14, v12
    v_mul_f32 v12, s35, v14
    v_fma_f32 v152, v152, s35, -v12
    v_fma_f32 v153, v153, s35, -v12
    v_fma_f32 v154, v154, s35, -v12
    v_fma_f32 v155, v155, s35, -v12
    v_fma_f32 v156, v156, s35, -v12
    v_fma_f32 v157, v157, s35, -v12
    v_fma_f32 v158, v158, s35, -v12
    v_exp_f32 v152, v152
    v_exp_f32 v153, v153
    v_exp_f32 v154, v154
    v_exp_f32 v155, v155
    v_exp_f32 v156, v156
    v_exp_f32 v157, v157
    v_exp_f32 v158, v158
    v_add_f32 v12, v152, v153
    v_add_f32 v13, v154, v155
    v_add_f32 v15, v156, v157
    v_add_f32 v12, v12, v158
    v_add_f32 v15, v15, v12
    v_add_f32 v15, v15, v13
    s_mov_b64 exec, s[98:99]
    ds_write_b64 v162, v[14:15] offset:6400
    s_mov_b64 exec, -1
    v_cvt_pk_bf16_f32 v152, v152, v152
    v_cvt_pk_bf16_f32 v153, v153, v153
    v_cvt_pk_bf16_f32 v154, v154, v154
    v_cvt_pk_bf16_f32 v155, v155, v155
    v_cvt_pk_bf16_f32 v156, v156, v156
    v_cvt_pk_bf16_f32 v157, v157, v157
    v_cvt_pk_bf16_f32 v158, v158, v158
    v_and_b32 v16, v152, v2
    v_and_b32 v17, v152, v3
    v_and_b32 v18, v152, v4
    v_and_b32 v19, v152, v5
    v_and_b32 v20, v153, v2
    v_and_b32 v21, v153, v3
    v_and_b32 v22, v153, v4
    v_and_b32 v23, v153, v5
    v_and_b32 v24, v154, v2
    v_and_b32 v25, v154, v3
    v_and_b32 v26, v154, v4
    v_and_b32 v27, v154, v5
    v_and_b32 v28, v155, v2
    v_and_b32 v29, v155, v3
    v_and_b32 v30, v155, v4
    v_and_b32 v31, v155, v5
    v_and_b32 v32, v156, v2
    v_and_b32 v33, v156, v3
    v_and_b32 v34, v156, v4
    v_and_b32 v35, v156, v5
    v_and_b32 v36, v157, v2
    v_and_b32 v37, v157, v3
    v_and_b32 v38, v157, v4
    v_and_b32 v39, v157, v5
    v_and_b32 v40, v158, v2
    v_and_b32 v41, v158, v3
    v_and_b32 v42, v158, v4
    v_and_b32 v43, v158, v5
    global_load_dwordx4 v[88:91], v120, s[52:53] nt
    s_add_u32 s52, s52, 36864
    s_addc_u32 s53, s53, 0
    s_waitcnt vmcnt(7)
    v_mfma_f32_16x16x32_bf16 v[8:11], v[16:19], v[44:47], 0
    s_waitcnt vmcnt(6)
    v_mfma_f32_16x16x32_bf16 v[8:11], v[20:23], v[48:51], v[8:11]
    s_waitcnt vmcnt(5)
    v_mfma_f32_16x16x32_bf16 v[8:11], v[24:27], v[52:55], v[8:11]
    s_waitcnt vmcnt(4)
    v_mfma_f32_16x16x32_bf16 v[8:11], v[28:31], v[56:59], v[8:11]
    s_waitcnt vmcnt(3)
    v_mfma_f32_16x16x32_bf16 v[8:11], v[32:35], v[60:63], v[8:11]
    s_waitcnt vmcnt(2)
    v_mfma_f32_16x16x32_bf16 v[8:11], v[36:39], v[64:67], v[8:11]
    s_waitcnt vmcnt(1)
    v_mfma_f32_16x16x32_bf16 v[8:11], v[40:43], v[68:71], v[8:11]
    s_nop 7
    ds_write_b128 v161, v[8:11] offset:8192
    s_waitcnt lgkmcnt(0)
    s_barrier
    s_barrier
    global_load_dwordx4 v[92:95], v120, s[52:53] nt
    s_add_u32 s52, s52, 36864
    s_addc_u32 s53, s53, 0
    global_load_dwordx4 v[96:99], v120, s[52:53] nt
    s_add_u32 s52, s52, 36864
    s_addc_u32 s53, s53, 0
    global_load_dwordx4 v[100:103], v120, s[52:53] nt
    global_load_dwordx4 v[104:107], v121, s[54:55] offset:0 nt
    global_load_dwordx4 v[108:111], v121, s[54:55] offset:1152 nt
    global_load_dwordx4 v[112:115], v121, s[54:55] offset:2304 nt
    global_load_dwordx4 v[116:119], v121, s[54:55] offset:3456 nt
    s_branch L_mlp_w
L_mlp_9:
    v_and_b32 v161, 8, v1
    v_lshlrev_b32 v160, 5, v161
    v_and_b32 v163, 0xf0, v6
    v_lshrrev_b32 v164, 4, v1
    v_lshl_add_u32 v162, v164, 3, v160
    v_add_u32 v160, v160, v163
    v_xor_b32 v163, 0x100, v160
    s_lshl_b32 s59, s3, 5
    v_add_u32 v162, s59, v162
    v_mov_b32 v164, 0x3db504f3
    s_lshl_b32 s59, s3, 10
    v_lshl_add_u32 v161, v1, 4, s59
    s_waitcnt vmcnt(2)
    global_load_dwordx4 v[28:31], v6, s[44:45] offset:768 nt
    s_waitcnt vmcnt(2)
    global_load_dwordx4 v[32:35], v6, s[44:45] offset:1024 nt
    s_waitcnt vmcnt(2)
    global_load_dwordx4 v[36:39], v6, s[44:45] offset:1280 nt
    s_waitcnt vmcnt(2)
    global_load_dwordx4 v[40:43], v6, s[44:45] offset:1536 nt
    s_waitcnt vmcnt(2)
    global_load_dwordx4 v[44:47], v6, s[44:45] offset:1792 nt
    s_waitcnt vmcnt(2)
    global_load_dwordx4 v[48:51], v6, s[44:45] offset:2048 nt
    s_waitcnt vmcnt(2)
    global_load_dwordx4 v[52:55], v6, s[46:47] offset:0 nt
    s_waitcnt vmcnt(2)
    global_load_dwordx4 v[56:59], v6, s[46:47] offset:256 nt
    s_waitcnt vmcnt(2)
    global_load_dwordx4 v[60:63], v6, s[46:47] offset:512 nt
    global_load_dwordx4 v[64:67], v6, s[46:47] offset:768 nt
    global_load_dwordx4 v[68:71], v6, s[46:47] offset:1024 nt
    global_load_dwordx4 v[72:75], v6, s[46:47] offset:1280 nt
    s_barrier
    ds_read_b128 v[144:147], v160 offset:5888
    ds_read_b128 v[148:151], v163 offset:5888
    global_load_dwordx4 v[76:79], v6, s[46:47] offset:1536 nt
    s_waitcnt lgkmcnt(0)
    v_dot2_f32_bf16 v152, v16, v144, 0
    v_dot2_f32_bf16 v12, v16, v148, 0
    v_dot2_f32_bf16 v152, v17, v145, v152
    v_dot2_f32_bf16 v12, v17, v149, v12
    v_dot2_f32_bf16 v152, v18, v146, v152
    v_dot2_f32_bf16 v12, v18, v150, v12
    v_dot2_f32_bf16 v152, v19, v147, v152
    v_dot2_f32_bf16 v12, v19, v151, v12
    v_dot2_f32_bf16 v153, v20, v144, 0
    v_dot2_f32_bf16 v13, v20, v148, 0
    v_dot2_f32_bf16 v153, v21, v145, v153
    v_add_f32_dpp v152, v12, v152 row_ror:8 row_mask:0xf bank_mask:0xf
    v_dot2_f32_bf16 v13, v21, v149, v13
    v_dot2_f32_bf16 v153, v22, v146, v153
    v_add_f32_dpp v152, v152, v152 quad_perm:[1,0,3,2] row_mask:0xf bank_mask:0xf
    v_dot2_f32_bf16 v13, v22, v150, v13
    v_dot2_f32_bf16 v153, v23, v147, v153
    v_add_f32_dpp v152, v152, v152 quad_perm:[2,3,0,1] row_mask:0xf bank_mask:0xf
    v_dot2_f32_bf16 v13, v23, v151, v13
    s_nop 0
    v_add_f32_dpp v152, v152, v152 row_half_mirror row_mask:0xf bank_mask:0xf
    v_cvt_pk_bf16_f32 v152, 0, v152
    v_mul_f32 v152, v152, v164
    v_cvt_pk_bf16_f32 v152, 0, v152
    v_add_f32_dpp v153, v13, v153 row_ror:8 row_mask:0xf bank_mask:0xf
    v_dot2_f32_bf16 v154, v24, v144, 0
    v_dot2_f32_bf16 v12, v24, v148, 0
    v_add_f32_dpp v153, v153, v153 quad_perm:[1,0,3,2] row_mask:0xf bank_mask:0xf
    v_dot2_f32_bf16 v154, v25, v145, v154
    v_dot2_f32_bf16 v12, v25, v149, v12
    v_add_f32_dpp v153, v153, v153 quad_perm:[2,3,0,1] row_mask:0xf bank_mask:0xf
    v_dot2_f32_bf16 v154, v26, v146, v154
    v_dot2_f32_bf16 v12, v26, v150, v12
    v_add_f32_dpp v153, v153, v153 row_half_mirror row_mask:0xf bank_mask:0xf
    v_cvt_pk_bf16_f32 v153, 0, v153
    v_mul_f32 v153, v153, v164
    v_cvt_pk_bf16_f32 v153, 0, v153
    v_dot2_f32_bf16 v154, v27, v147, v154
    v_dot2_f32_bf16 v12, v27, v151, v12
    v_dot2_f32_bf16 v155, v28, v144, 0
    v_dot2_f32_bf16 v13, v28, v148, 0
    v_dot2_f32_bf16 v155, v29, v145, v155
    v_add_f32_dpp v154, v12, v154 row_ror:8 row_mask:0xf bank_mask:0xf
    v_dot2_f32_bf16 v13, v29, v149, v13
    v_dot2_f32_bf16 v155, v30, v146, v155
    v_add_f32_dpp v154, v154, v154 quad_perm:[1,0,3,2] row_mask:0xf bank_mask:0xf
    v_dot2_f32_bf16 v13, v30, v150, v13
    v_dot2_f32_bf16 v155, v31, v147, v155
    v_add_f32_dpp v154, v154, v154 quad_perm:[2,3,0,1] row_mask:0xf bank_mask:0xf
    v_dot2_f32_bf16 v13, v31, v151, v13
    s_nop 0
    v_add_f32_dpp v154, v154, v154 row_half_mirror row_mask:0xf bank_mask:0xf
    v_cvt_pk_bf16_f32 v154, 0, v154
    v_mul_f32 v154, v154, v164
    v_cvt_pk_bf16_f32 v154, 0, v154
    v_add_f32_dpp v155, v13, v155 row_ror:8 row_mask:0xf bank_mask:0xf
    v_dot2_f32_bf16 v156, v32, v144, 0
    v_dot2_f32_bf16 v12, v32, v148, 0
    v_add_f32_dpp v155, v155, v155 quad_perm:[1,0,3,2] row_mask:0xf bank_mask:0xf
    v_dot2_f32_bf16 v156, v33, v145, v156
    v_dot2_f32_bf16 v12, v33, v149, v12
    v_add_f32_dpp v155, v155, v155 quad_perm:[2,3,0,1] row_mask:0xf bank_mask:0xf
    v_dot2_f32_bf16 v156, v34, v146, v156
    v_dot2_f32_bf16 v12, v34, v150, v12
    v_add_f32_dpp v155, v155, v155 row_half_mirror row_mask:0xf bank_mask:0xf
    v_cvt_pk_bf16_f32 v155, 0, v155
    v_mul_f32 v155, v155, v164
    v_cvt_pk_bf16_f32 v155, 0, v155
    v_dot2_f32_bf16 v156, v35, v147, v156
    v_dot2_f32_bf16 v12, v35, v151, v12
    v_dot2_f32_bf16 v157, v36, v144, 0
    v_dot2_f32_bf16 v13, v36, v148, 0
    v_dot2_f32_bf16 v157, v37, v145, v157
    v_add_f32_dpp v156, v12, v156 row_ror:8 row_mask:0xf bank_mask:0xf
    v_dot2_f32_bf16 v13, v37, v149, v13
    v_dot2_f32_bf16 v157, v38, v146, v157
    v_add_f32_dpp v156, v156, v156 quad_perm:[1,0,3,2] row_mask:0xf bank_mask:0xf
    v_dot2_f32_bf16 v13, v38, v150, v13
    v_dot2_f32_bf16 v157, v39, v147, v157
    v_add_f32_dpp v156, v156, v156 quad_perm:[2,3,0,1] row_mask:0xf bank_mask:0xf
    v_dot2_f32_bf16 v13, v39, v151, v13
    s_nop 0
    v_add_f32_dpp v156, v156, v156 row_half_mirror row_mask:0xf bank_mask:0xf
    v_cvt_pk_bf16_f32 v156, 0, v156
    v_mul_f32 v156, v156, v164
    v_cvt_pk_bf16_f32 v156, 0, v156
    v_add_f32_dpp v157, v13, v157 row_ror:8 row_mask:0xf bank_mask:0xf
    v_dot2_f32_bf16 v158, v40, v144, 0
    v_dot2_f32_bf16 v12, v40, v148, 0
    v_add_f32_dpp v157, v157, v157 quad_perm:[1,0,3,2] row_mask:0xf bank_mask:0xf
    v_dot2_f32_bf16 v158, v41, v145, v158
    v_dot2_f32_bf16 v12, v41, v149, v12
    v_add_f32_dpp v157, v157, v157 quad_perm:[2,3,0,1] row_mask:0xf bank_mask:0xf
    v_dot2_f32_bf16 v158, v42, v146, v158
    v_dot2_f32_bf16 v12, v42, v150, v12
    v_add_f32_dpp v157, v157, v157 row_half_mirror row_mask:0xf bank_mask:0xf
    v_cvt_pk_bf16_f32 v157, 0, v157
    v_mul_f32 v157, v157, v164
    v_cvt_pk_bf16_f32 v157, 0, v157
    v_dot2_f32_bf16 v158, v43, v147, v158
    v_dot2_f32_bf16 v12, v43, v151, v12
    v_dot2_f32_bf16 v159, v44, v144, 0
    v_dot2_f32_bf16 v13, v44, v148, 0
    v_dot2_f32_bf16 v159, v45, v145, v159
    v_add_f32_dpp v158, v12, v158 row_ror:8 row_mask:0xf bank_mask:0xf
    v_dot2_f32_bf16 v13, v45, v149, v13
    v_dot2_f32_bf16 v159, v46, v146, v159
    v_add_f32_dpp v158, v158, v158 quad_perm:[1,0,3,2] row_mask:0xf bank_mask:0xf
    v_dot2_f32_bf16 v13, v46, v150, v13
    v_dot2_f32_bf16 v159, v47, v147, v159
    v_add_f32_dpp v158, v158, v158 quad_perm:[2,3,0,1] row_mask:0xf bank_mask:0xf
    v_dot2_f32_bf16 v13, v47, v151, v13
    s_nop 0
    v_add_f32_dpp v158, v158, v158 row_half_mirror row_mask:0xf bank_mask:0xf
    v_cvt_pk_bf16_f32 v158, 0, v158
    v_mul_f32 v158, v158, v164
    v_cvt_pk_bf16_f32 v158, 0, v158
    v_add_f32_dpp v159, v13, v159 row_ror:8 row_mask:0xf bank_mask:0xf
    v_dot2_f32_bf16 v137, v48, v144, 0
    v_dot2_f32_bf16 v12, v48, v148, 0
    v_add_f32_dpp v159, v159, v159 quad_perm:[1,0,3,2] row_mask:0xf bank_mask:0xf
    v_dot2_f32_bf16 v137, v49, v145, v137
    v_dot2_f32_bf16 v12, v49, v149, v12
    v_add_f32_dpp v159, v159, v159 quad_perm:[2,3,0,1] row_mask:0xf bank_mask:0xf
    v_dot2_f32_bf16 v137, v50, v146, v137
    v_dot2_f32_bf16 v12, v50, v150, v12
    v_add_f32_dpp v159, v159, v159 row_half_mirror row_mask:0xf bank_mask:0xf
    v_cvt_pk_bf16_f32 v159, 0, v159
    v_mul_f32 v159, v159, v164
    v_cvt_pk_bf16_f32 v159, 0, v159
    v_dot2_f32_bf16 v137, v51, v147, v137
    v_dot2_f32_bf16 v12, v51, v151, v12
    v_max3_f32 v14, v152, v153, v154
    v_max3_f32 v14, v14, v155, v156
    v_max3_f32 v14, v14, v157, v158
    v_add_f32_dpp v137, v12, v137 row_ror:8 row_mask:0xf bank_mask:0xf
    s_nop 1
    v_add_f32_dpp v137, v137, v137 quad_perm:[1,0,3,2] row_mask:0xf bank_mask:0xf
    s_nop 1
    v_add_f32_dpp v137, v137, v137 quad_perm:[2,3,0,1] row_mask:0xf bank_mask:0xf
    s_nop 1
    v_add_f32_dpp v137, v137, v137 row_half_mirror row_mask:0xf bank_mask:0xf
    v_cvt_pk_bf16_f32 v137, 0, v137
    v_mul_f32 v137, v137, v164
    v_cvt_pk_bf16_f32 v137, 0, v137
    v_max3_f32 v14, v14, v159, v137
    v_mov_b32 v12, v14
    s_nop 1
    v_permlane32_swap_b32 v12, v14
    v_max_f32 v14, v14, v12
    v_mov_b32 v12, v14
    s_nop 1
    v_permlane16_swap_b32 v12, v14
    v_max_f32 v14, v14, v12
    v_mul_f32 v12, s35, v14
    v_fma_f32 v152, v152, s35, -v12
    v_fma_f32 v153, v153, s35, -v12
    v_fma_f32 v154, v154, s35, -v12
    v_fma_f32 v155, v155, s35, -v12
    v_fma_f32 v156, v156, s35, -v12
    v_fma_f32 v157, v157, s35, -v12
    v_fma_f32 v158, v158, s35, -v12
    v_fma_f32 v159, v159, s35, -v12
    v_fma_f32 v137, v137, s35, -v12
    v_exp_f32 v152, v152
    v_exp_f32 v153, v153
    v_exp_f32 v154, v154
    v_exp_f32 v155, v155
    v_exp_f32 v156, v156
    v_exp_f32 v157, v157
    v_exp_f32 v158, v158
    v_exp_f32 v159, v159
    v_exp_f32 v137, v137
    v_add_f32 v12, v152, v153
    v_add_f32 v13, v154, v155
    v_add_f32 v15, v156, v157
    v_add_f32 v12, v12, v158
    v_add_f32 v13, v13, v159
    v_add_f32 v15, v15, v137
    v_add_f32 v15, v15, v12
    v_add_f32 v15, v15, v13
    s_mov_b64 exec, s[98:99]
    ds_write_b64 v162, v[14:15] offset:6400
    s_mov_b64 exec, -1
    v_cvt_pk_bf16_f32 v152, v152, v152
    v_cvt_pk_bf16_f32 v153, v153, v153
    v_cvt_pk_bf16_f32 v154, v154, v154
    v_cvt_pk_bf16_f32 v155, v155, v155
    v_cvt_pk_bf16_f32 v156, v156, v156
    v_cvt_pk_bf16_f32 v157, v157, v157
    v_cvt_pk_bf16_f32 v158, v158, v158
    v_cvt_pk_bf16_f32 v159, v159, v159
    v_cvt_pk_bf16_f32 v137, v137, v137
    v_and_b32 v16, v152, v2
    v_and_b32 v17, v152, v3
    v_and_b32 v18, v152, v4
    v_and_b32 v19, v152, v5
    v_and_b32 v20, v153, v2
    v_and_b32 v21, v153, v3
    v_and_b32 v22, v153, v4
    v_and_b32 v23, v153, v5
    v_and_b32 v24, v154, v2
    v_and_b32 v25, v154, v3
    v_and_b32 v26, v154, v4
    v_and_b32 v27, v154, v5
    v_and_b32 v28, v155, v2
    v_and_b32 v29, v155, v3
    v_and_b32 v30, v155, v4
    v_and_b32 v31, v155, v5
    v_and_b32 v32, v156, v2
    v_and_b32 v33, v156, v3
    v_and_b32 v34, v156, v4
    v_and_b32 v35, v156, v5
    v_and_b32 v36, v157, v2
    v_and_b32 v37, v157, v3
    v_and_b32 v38, v157, v4
    v_and_b32 v39, v157, v5
    v_and_b32 v40, v158, v2
    v_and_b32 v41, v158, v3
    v_and_b32 v42, v158, v4
    v_and_b32 v43, v158, v5
    v_and_b32 v44, v159, v2
    v_and_b32 v45, v159, v3
    v_and_b32 v46, v159, v4
    v_and_b32 v47, v159, v5
    v_and_b32 v48, v137, v2
    v_and_b32 v49, v137, v3
    v_and_b32 v50, v137, v4
    v_and_b32 v51, v137, v5
    global_load_dwordx4 v[80:83], v6, s[46:47] offset:1792 nt
    global_load_dwordx4 v[84:87], v6, s[46:47] offset:2048 nt
    global_load_dwordx4 v[88:91], v120, s[52:53] nt
    s_add_u32 s52, s52, 36864
    s_addc_u32 s53, s53, 0
    s_waitcnt vmcnt(9)
    v_mfma_f32_16x16x32_bf16 v[8:11], v[16:19], v[52:55], 0
    s_waitcnt vmcnt(8)
    v_mfma_f32_16x16x32_bf16 v[8:11], v[20:23], v[56:59], v[8:11]
    s_waitcnt vmcnt(7)
    v_mfma_f32_16x16x32_bf16 v[8:11], v[24:27], v[60:63], v[8:11]
    s_waitcnt vmcnt(6)
    v_mfma_f32_16x16x32_bf16 v[8:11], v[28:31], v[64:67], v[8:11]
    s_waitcnt vmcnt(5)
    v_mfma_f32_16x16x32_bf16 v[8:11], v[32:35], v[68:71], v[8:11]
    s_waitcnt vmcnt(4)
    v_mfma_f32_16x16x32_bf16 v[8:11], v[36:39], v[72:75], v[8:11]
    s_waitcnt vmcnt(3)
    v_mfma_f32_16x16x32_bf16 v[8:11], v[40:43], v[76:79], v[8:11]
    s_waitcnt vmcnt(2)
    v_mfma_f32_16x16x32_bf16 v[8:11], v[44:47], v[80:83], v[8:11]
    s_waitcnt vmcnt(1)
    v_mfma_f32_16x16x32_bf16 v[8:11], v[48:51], v[84:87], v[8:11]
    s_nop 7
    ds_write_b128 v161, v[8:11] offset:8192
    s_waitcnt lgkmcnt(0)
    s_barrier
    s_barrier
    global_load_dwordx4 v[92:95], v120, s[52:53] nt
    s_add_u32 s52, s52, 36864
    s_addc_u32 s53, s53, 0
    global_load_dwordx4 v[96:99], v120, s[52:53] nt
    s_add_u32 s52, s52, 36864
    s_addc_u32 s53, s53, 0
    global_load_dwordx4 v[100:103], v120, s[52:53] nt
    global_load_dwordx4 v[104:107], v121, s[54:55] offset:0 nt
    global_load_dwordx4 v[108:111], v121, s[54:55] offset:1152 nt
    global_load_dwordx4 v[112:115], v121, s[54:55] offset:2304 nt
    global_load_dwordx4 v[116:119], v121, s[54:55] offset:3456 nt
    s_branch L_mlp_w
L_wo:
    v_and_b32 v122, 0x30, v1
    v_bfe_u32 v123, v1, 3, 1
    v_lshl_add_u32 v123, v123, 1, v122
    v_and_b32 v112, 0x70, v6
    v_mov_b32 v124, 1152
    v_mad_u32_u24 v112, v123, v124, v112
    s_lshl3_add_u32 s59, s42, s3
    s_mul_i32 s59, s59, 73728
    s_lshl_b32 s60, s38, 7
    s_add_u32 s59, s59, s60
    s_add_u32 s59, s59, 2880
    s_add_u32 s52, s12, s59
    s_addc_u32 s53, s13, 0
    s_add_u32 s54, s52, 9216
    s_addc_u32 s55, s53, 0
    v_and_b32 v113, 0x30, v6
    v_lshl_add_u32 v113, v122, 2, v113
    v_and_b32 v123, 12, v1
    v_lshl_add_u32 v113, v123, 10, v113
    s_lshr_b32 s59, s3, 2
    s_lshl1_add_u32 s59, s42, s59
    s_lshl_b32 s60, s59, 14
    s_and_b32 s61, s3, 3
    s_lshl_b32 s61, s61, 8
    s_add_u32 s60, s60, s61
    s_add_u32 s60, s60, 0x40000
    v_add_u32 v113, s60, v113
    s_lshl_b32 s59, s59, 8
    s_add_u32 s59, s59, 0x30000
    v_and_b32 v114, 0xf0, v6
    v_add_u32 v114, s59, v114
L_wo_5:
    v_and_b32 v161, 8, v1
    v_lshlrev_b32 v160, 5, v161
    v_and_b32 v163, 0xf0, v6
    v_lshrrev_b32 v164, 4, v1
    v_lshl_add_u32 v162, v164, 3, v160
    v_add_u32 v160, v160, v163
    v_xor_b32 v163, 0x100, v160
    s_lshl_b32 s59, s3, 5
    v_add_u32 v162, s59, v162
    v_mov_b32 v164, 0x3db504f3
    s_lshl_b32 s59, s3, 10
    v_lshl_add_u32 v161, v1, 4, s59
    s_waitcnt vmcnt(2)
    global_load_dwordx4 v[28:31], v6, s[44:45] offset:768 nt
    s_waitcnt vmcnt(2)
    global_load_dwordx4 v[32:35], v6, s[44:45] offset:1024 nt
    s_waitcnt vmcnt(2)
    global_load_dwordx4 v[36:39], v6, s[46:47] offset:0 nt
    s_waitcnt vmcnt(2)
    global_load_dwordx4 v[40:43], v6, s[46:47] offset:256 nt
    s_waitcnt vmcnt(2)
    global_load_dwordx4 v[44:47], v6, s[46:47] offset:512 nt
    s_waitcnt vmcnt(2)
    global_load_dwordx4 v[48:51], v6, s[46:47] offset:768 nt
    s_waitcnt vmcnt(2)
    global_load_dwordx4 v[52:55], v6, s[46:47] offset:1024 nt
    s_waitcnt vmcnt(2)
    global_load_dwordx4 v[80:83], v112, s[52:53] offset:-2880 nt
    s_waitcnt vmcnt(2)
    global_load_dwordx4 v[84:87], v112, s[52:53] offset:-1728 nt
    global_load_dwordx4 v[88:91], v112, s[52:53] offset:1728 nt
    global_load_dwordx4 v[92:95], v112, s[52:53] offset:2880 nt
    global_load_dwordx4 v[96:99], v112, s[54:55] offset:-2880 nt
    s_barrier
    ds_read_b128 v[144:147], v160 offset:5888
    ds_read_b128 v[148:151], v163 offset:5888
    global_load_dwordx4 v[100:103], v112, s[54:55] offset:-1728 nt
    s_waitcnt lgkmcnt(0)
    v_dot2_f32_bf16 v152, v16, v144, 0
    v_dot2_f32_bf16 v12, v16, v148, 0
    v_dot2_f32_bf16 v152, v17, v145, v152
    v_dot2_f32_bf16 v12, v17, v149, v12
    v_dot2_f32_bf16 v152, v18, v146, v152
    v_dot2_f32_bf16 v12, v18, v150, v12
    v_dot2_f32_bf16 v152, v19, v147, v152
    v_dot2_f32_bf16 v12, v19, v151, v12
    v_dot2_f32_bf16 v153, v20, v144, 0
    v_dot2_f32_bf16 v13, v20, v148, 0
    v_dot2_f32_bf16 v153, v21, v145, v153
    v_add_f32_dpp v152, v12, v152 row_ror:8 row_mask:0xf bank_mask:0xf
    v_dot2_f32_bf16 v13, v21, v149, v13
    v_dot2_f32_bf16 v153, v22, v146, v153
    v_add_f32_dpp v152, v152, v152 quad_perm:[1,0,3,2] row_mask:0xf bank_mask:0xf
    v_dot2_f32_bf16 v13, v22, v150, v13
    v_dot2_f32_bf16 v153, v23, v147, v153
    v_add_f32_dpp v152, v152, v152 quad_perm:[2,3,0,1] row_mask:0xf bank_mask:0xf
    v_dot2_f32_bf16 v13, v23, v151, v13
    s_nop 0
    v_add_f32_dpp v152, v152, v152 row_half_mirror row_mask:0xf bank_mask:0xf
    v_cvt_pk_bf16_f32 v152, 0, v152
    v_mul_f32 v152, v152, v164
    v_cvt_pk_bf16_f32 v152, 0, v152
    v_add_f32_dpp v153, v13, v153 row_ror:8 row_mask:0xf bank_mask:0xf
    v_dot2_f32_bf16 v154, v24, v144, 0
    v_dot2_f32_bf16 v12, v24, v148, 0
    v_add_f32_dpp v153, v153, v153 quad_perm:[1,0,3,2] row_mask:0xf bank_mask:0xf
    v_dot2_f32_bf16 v154, v25, v145, v154
    v_dot2_f32_bf16 v12, v25, v149, v12
    v_add_f32_dpp v153, v153, v153 quad_perm:[2,3,0,1] row_mask:0xf bank_mask:0xf
    v_dot2_f32_bf16 v154, v26, v146, v154
    v_dot2_f32_bf16 v12, v26, v150, v12
    v_add_f32_dpp v153, v153, v153 row_half_mirror row_mask:0xf bank_mask:0xf
    v_cvt_pk_bf16_f32 v153, 0, v153
    v_mul_f32 v153, v153, v164
    v_cvt_pk_bf16_f32 v153, 0, v153
    v_dot2_f32_bf16 v154, v27, v147, v154
    v_dot2_f32_bf16 v12, v27, v151, v12
    v_dot2_f32_bf16 v155, v28, v144, 0
    v_dot2_f32_bf16 v13, v28, v148, 0
    v_dot2_f32_bf16 v155, v29, v145, v155
    v_add_f32_dpp v154, v12, v154 row_ror:8 row_mask:0xf bank_mask:0xf
    v_dot2_f32_bf16 v13, v29, v149, v13
    v_dot2_f32_bf16 v155, v30, v146, v155
    v_add_f32_dpp v154, v154, v154 quad_perm:[1,0,3,2] row_mask:0xf bank_mask:0xf
    v_dot2_f32_bf16 v13, v30, v150, v13
    v_dot2_f32_bf16 v155, v31, v147, v155
    v_add_f32_dpp v154, v154, v154 quad_perm:[2,3,0,1] row_mask:0xf bank_mask:0xf
    v_dot2_f32_bf16 v13, v31, v151, v13
    s_nop 0
    v_add_f32_dpp v154, v154, v154 row_half_mirror row_mask:0xf bank_mask:0xf
    v_cvt_pk_bf16_f32 v154, 0, v154
    v_mul_f32 v154, v154, v164
    v_cvt_pk_bf16_f32 v154, 0, v154
    v_add_f32_dpp v155, v13, v155 row_ror:8 row_mask:0xf bank_mask:0xf
    v_dot2_f32_bf16 v156, v32, v144, 0
    v_dot2_f32_bf16 v12, v32, v148, 0
    v_add_f32_dpp v155, v155, v155 quad_perm:[1,0,3,2] row_mask:0xf bank_mask:0xf
    v_dot2_f32_bf16 v156, v33, v145, v156
    v_dot2_f32_bf16 v12, v33, v149, v12
    v_add_f32_dpp v155, v155, v155 quad_perm:[2,3,0,1] row_mask:0xf bank_mask:0xf
    v_dot2_f32_bf16 v156, v34, v146, v156
    v_dot2_f32_bf16 v12, v34, v150, v12
    v_add_f32_dpp v155, v155, v155 row_half_mirror row_mask:0xf bank_mask:0xf
    v_cvt_pk_bf16_f32 v155, 0, v155
    v_mul_f32 v155, v155, v164
    v_cvt_pk_bf16_f32 v155, 0, v155
    v_dot2_f32_bf16 v156, v35, v147, v156
    v_dot2_f32_bf16 v12, v35, v151, v12
    v_max3_f32 v14, v152, v153, v154
    s_nop 1
    v_add_f32_dpp v156, v12, v156 row_ror:8 row_mask:0xf bank_mask:0xf
    s_nop 1
    v_add_f32_dpp v156, v156, v156 quad_perm:[1,0,3,2] row_mask:0xf bank_mask:0xf
    s_nop 1
    v_add_f32_dpp v156, v156, v156 quad_perm:[2,3,0,1] row_mask:0xf bank_mask:0xf
    s_nop 1
    v_add_f32_dpp v156, v156, v156 row_half_mirror row_mask:0xf bank_mask:0xf
    v_cvt_pk_bf16_f32 v156, 0, v156
    v_mul_f32 v156, v156, v164
    v_cvt_pk_bf16_f32 v156, 0, v156
    v_max3_f32 v14, v14, v155, v156
    v_mov_b32 v12, v14
    s_nop 1
    v_permlane32_swap_b32 v12, v14
    v_max_f32 v14, v14, v12
    v_mov_b32 v12, v14
    s_nop 1
    v_permlane16_swap_b32 v12, v14
    v_max_f32 v14, v14, v12
    v_mul_f32 v12, s35, v14
    v_fma_f32 v152, v152, s35, -v12
    v_fma_f32 v153, v153, s35, -v12
    v_fma_f32 v154, v154, s35, -v12
    v_fma_f32 v155, v155, s35, -v12
    v_fma_f32 v156, v156, s35, -v12
    v_exp_f32 v152, v152
    v_exp_f32 v153, v153
    v_exp_f32 v154, v154
    v_exp_f32 v155, v155
    v_exp_f32 v156, v156
    v_add_f32 v13, v152, v153
    v_add_f32 v15, v154, v155
    v_add_f32 v13, v13, v156
    v_add_f32 v15, v15, v13
    s_mov_b64 exec, s[98:99]
    ds_write_b64 v162, v[14:15] offset:6400
    s_mov_b64 exec, -1
    v_cvt_pk_bf16_f32 v152, v152, v152
    v_cvt_pk_bf16_f32 v153, v153, v153
    v_cvt_pk_bf16_f32 v154, v154, v154
    v_cvt_pk_bf16_f32 v155, v155, v155
    v_cvt_pk_bf16_f32 v156, v156, v156
    v_and_b32 v16, v152, v2
    v_and_b32 v17, v152, v3
    v_and_b32 v18, v152, v4
    v_and_b32 v19, v152, v5
    v_and_b32 v20, v153, v2
    v_and_b32 v21, v153, v3
    v_and_b32 v22, v153, v4
    v_and_b32 v23, v153, v5
    v_and_b32 v24, v154, v2
    v_and_b32 v25, v154, v3
    v_and_b32 v26, v154, v4
    v_and_b32 v27, v154, v5
    v_and_b32 v28, v155, v2
    v_and_b32 v29, v155, v3
    v_and_b32 v30, v155, v4
    v_and_b32 v31, v155, v5
    v_and_b32 v32, v156, v2
    v_and_b32 v33, v156, v3
    v_and_b32 v34, v156, v4
    v_and_b32 v35, v156, v5
    global_load_dwordx4 v[104:107], v112, s[54:55] offset:1728 nt
    global_load_dwordx4 v[108:111], v112, s[54:55] offset:2880 nt
    v_mfma_f32_16x16x32_bf16 v[8:11], v[16:19], v[36:39], 0
    v_mfma_f32_16x16x32_bf16 v[8:11], v[20:23], v[40:43], v[8:11]
    v_mfma_f32_16x16x32_bf16 v[8:11], v[24:27], v[44:47], v[8:11]
    v_mfma_f32_16x16x32_bf16 v[8:11], v[28:31], v[48:51], v[8:11]
    s_waitcnt vmcnt(8)
    v_mfma_f32_16x16x32_bf16 v[8:11], v[32:35], v[52:55], v[8:11]
    s_nop 7
    ds_write_b128 v161, v[8:11] offset:8192
    s_waitcnt lgkmcnt(0)
    s_barrier
    s_barrier
L_wo_w:
    s_mov_b64 s[52:53], -1
    s_mov_b64 s[44:45], -1
    s_mov_b64 s[46:47], -1
    s_mov_b64 s[48:49], -1
    s_mov_b64 s[50:51], -1
    s_movk_i32 s58, 0x2000
L_ml_poll:
    s_mov_b64 exec, s[52:53]
    global_load_dwordx4 v[64:67], v114, s[0:1] sc1
    s_mov_b64 exec, s[44:45]
    global_load_dwordx4 v[48:51], v113, s[0:1] offset:0 sc1
    s_mov_b64 exec, s[46:47]
    global_load_dwordx4 v[52:55], v113, s[0:1] offset:1024 sc1
    s_mov_b64 exec, s[48:49]
    global_load_dwordx4 v[56:59], v113, s[0:1] offset:2048 sc1
    s_mov_b64 exec, s[50:51]
    global_load_dwordx4 v[60:63], v113, s[0:1] offset:3072 sc1
L_ml_poll_w:
    s_waitcnt vmcnt(4)
    s_mov_b64 exec, s[52:53]
    v_xor_b32 v64, s31, v64
    v_xor_b32 v65, s32, v65
    v_xor_b32 v66, s33, v66
    v_xor_b32 v67, s34, v67
    v_or3_b32 v12, v64, v65, v66
    v_or_b32 v12, v12, v67
    v_and_b32 v12, 0xff, v12
    v_cmp_ne_u32 s[52:53], 0, v12
    s_waitcnt vmcnt(3)
    s_mov_b64 exec, s[44:45]
    v_xor_b32 v48, s31, v48
    v_xor_b32 v49, s32, v49
    v_xor_b32 v50, s33, v50
    v_xor_b32 v51, s34, v51
    v_or3_b32 v12, v48, v49, v50
    v_or_b32 v12, v12, v51
    v_and_b32 v12, 0xff, v12
    v_cmp_ne_u32 s[44:45], 0, v12
    s_waitcnt vmcnt(2)
    s_mov_b64 exec, s[46:47]
    v_xor_b32 v52, s31, v52
    v_xor_b32 v53, s32, v53
    v_xor_b32 v54, s33, v54
    v_xor_b32 v55, s34, v55
    v_or3_b32 v12, v52, v53, v54
    v_or_b32 v12, v12, v55
    v_and_b32 v12, 0xff, v12
    v_cmp_ne_u32 s[46:47], 0, v12
    s_waitcnt vmcnt(1)
    s_mov_b64 exec, s[48:49]
    v_xor_b32 v56, s31, v56
    v_xor_b32 v57, s32, v57
    v_xor_b32 v58, s33, v58
    v_xor_b32 v59, s34, v59
    v_or3_b32 v12, v56, v57, v58
    v_or_b32 v12, v12, v59
    v_and_b32 v12, 0xff, v12
    v_cmp_ne_u32 s[48:49], 0, v12
    s_waitcnt vmcnt(0)
    s_mov_b64 exec, s[50:51]
    v_xor_b32 v60, s31, v60
    v_xor_b32 v61, s32, v61
    v_xor_b32 v62, s33, v62
    v_xor_b32 v63, s34, v63
    v_or3_b32 v12, v60, v61, v62
    v_or_b32 v12, v12, v63
    v_and_b32 v12, 0xff, v12
    v_cmp_ne_u32 s[50:51], 0, v12
    s_cmp_lg_u64 s[52:53], 0
    s_cbranch_scc0 L_ml_poll_x
    s_sub_u32 s58, s58, 1
    s_cbranch_scc1 L_ml_poll_x
    s_cmp_lg_u32 s58, 0x1fc0
    s_cbranch_scc1 L_ml_poll
    s_mov_b64 s[0:1], s[100:101]
    s_branch L_ml_poll
L_ml_poll_x:
    s_mov_b64 exec, -1
    s_mov_b64 exec, s[44:45]
    global_load_dwordx4 v[48:51], v113, s[0:1] offset:0 sc1
    s_mov_b64 exec, s[46:47]
    global_load_dwordx4 v[52:55], v113, s[0:1] offset:1024 sc1
    s_mov_b64 exec, s[48:49]
    global_load_dwordx4 v[56:59], v113, s[0:1] offset:2048 sc1
    s_mov_b64 exec, s[50:51]
    global_load_dwordx4 v[60:63], v113, s[0:1] offset:3072 sc1
    s_mov_b64 exec, -1
    s_bitcmp0_b32 s3, 1
    s_cbranch_scc1 L_wo_h0
    v_mov_b32 v64, v66
    v_mov_b32 v65, v67
L_wo_h0:
    v_mov_b32 v66, v64
    s_nop 1
    v_max_f32_dpp v66, v66, v66 quad_perm:[1,0,3,2] row_mask:0xf bank_mask:0xf
    s_nop 1
    v_max_f32_dpp v66, v66, v66 quad_perm:[2,3,0,1] row_mask:0xf bank_mask:0xf
    s_nop 1
    v_max_f32_dpp v66, v66, v66 row_half_mirror row_mask:0xf bank_mask:0xf
    s_nop 1
    v_max_f32_dpp v66, v66, v66 row_mirror row_mask:0xf bank_mask:0xf
    v_sub_f32 v64, v64, v66
    v_mul_f32 v64, s35, v64
    v_exp_f32 v64, v64
    s_nop 0
    v_mul_f32 v65, v65, v64
    s_nop 1
    v_add_f32_dpp v65, v65, v65 quad_perm:[1,0,3,2] row_mask:0xf bank_mask:0xf
    s_nop 1
    v_add_f32_dpp v65, v65, v65 quad_perm:[2,3,0,1] row_mask:0xf bank_mask:0xf
    s_nop 1
    v_add_f32_dpp v65, v65, v65 row_half_mirror row_mask:0xf bank_mask:0xf
    s_nop 1
    v_add_f32_dpp v65, v65, v65 row_mirror row_mask:0xf bank_mask:0xf
    v_rcp_f32 v65, v65
    s_nop 0
    v_mul_f32 v64, v64, v65
    s_nop 1
    v_mov_b32_dpp v68, v64 quad_perm:[0,0,0,0] row_mask:0xf bank_mask:0xf
    v_mov_b32_dpp v69, v64 quad_perm:[1,1,1,1] row_mask:0xf bank_mask:0xf
    v_mov_b32_dpp v70, v64 quad_perm:[2,2,2,2] row_mask:0xf bank_mask:0xf
    v_mov_b32_dpp v71, v64 quad_perm:[3,3,3,3] row_mask:0xf bank_mask:0xf
    s_movk_i32 s58, 0x2000
    s_branch L_wo_poll_w
L_wo_poll:
    s_mov_b64 exec, s[44:45]
    global_load_dwordx4 v[48:51], v113, s[0:1] offset:0 sc1
    s_mov_b64 exec, s[46:47]
    global_load_dwordx4 v[52:55], v113, s[0:1] offset:1024 sc1
    s_mov_b64 exec, s[48:49]
    global_load_dwordx4 v[56:59], v113, s[0:1] offset:2048 sc1
    s_mov_b64 exec, s[50:51]
    global_load_dwordx4 v[60:63], v113, s[0:1] offset:3072 sc1
L_wo_poll_w:
    s_waitcnt vmcnt(3)
    s_mov_b64 exec, s[44:45]
    v_xor_b32 v48, s31, v48
    v_xor_b32 v49, s32, v49
    v_xor_b32 v50, s33, v50
    v_xor_b32 v51, s34, v51
    v_or3_b32 v12, v48, v49, v50
    v_or_b32 v12, v12, v51
    v_and_b32 v12, 0xff, v12
    v_cmp_ne_u32 s[44:45], 0, v12
    s_waitcnt vmcnt(2)
    s_mov_b64 exec, s[46:47]
    v_xor_b32 v52, s31, v52
    v_xor_b32 v53, s32, v53
    v_xor_b32 v54, s33, v54
    v_xor_b32 v55, s34, v55
    v_or3_b32 v12, v52, v53, v54
    v_or_b32 v12, v12, v55
    v_and_b32 v12, 0xff, v12
    v_cmp_ne_u32 s[46:47], 0, v12
    s_waitcnt vmcnt(1)
    s_mov_b64 exec, s[48:49]
    v_xor_b32 v56, s31, v56
    v_xor_b32 v57, s32, v57
    v_xor_b32 v58, s33, v58
    v_xor_b32 v59, s34, v59
    v_or3_b32 v12, v56, v57, v58
    v_or_b32 v12, v12, v59
    v_and_b32 v12, 0xff, v12
    v_cmp_ne_u32 s[48:49], 0, v12
    s_waitcnt vmcnt(0)
    s_mov_b64 exec, s[50:51]
    v_xor_b32 v60, s31, v60
    v_xor_b32 v61, s32, v61
    v_xor_b32 v62, s33, v62
    v_xor_b32 v63, s34, v63
    v_or3_b32 v12, v60, v61, v62
    v_or_b32 v12, v12, v63
    v_and_b32 v12, 0xff, v12
    v_cmp_ne_u32 s[50:51], 0, v12
    s_or_b64 vcc, s[44:45], s[46:47]
    s_or_b64 vcc, vcc, s[48:49]
    s_or_b64 vcc, vcc, s[50:51]
    s_cbranch_scc0 L_wo_poll_x
    s_sub_u32 s58, s58, 1
    s_cbranch_scc1 L_wo_poll_x
    s_cmp_lg_u32 s58, 0x1fc0
    s_cbranch_scc1 L_wo_poll
    s_mov_b64 s[0:1], s[100:101]
    s_branch L_wo_poll
L_wo_poll_x:
    s_mov_b64 exec, -1
    s_waitcnt lgkmcnt(0)
    v_pk_mul_f32 v[48:49], v[48:49], v[68:69] op_sel:[0,0] op_sel_hi:[1,0]
    v_pk_mul_f32 v[50:51], v[50:51], v[68:69] op_sel:[0,0] op_sel_hi:[1,0]
    v_pk_fma_f32 v[48:49], v[52:53], v[68:69], v[48:49] op_sel:[0,1,0] op_sel_hi:[1,1,1]
    v_pk_fma_f32 v[50:51], v[54:55], v[68:69], v[50:51] op_sel:[0,1,0] op_sel_hi:[1,1,1]
    v_pk_fma_f32 v[48:49], v[56:57], v[70:71], v[48:49] op_sel:[0,0,0] op_sel_hi:[1,0,1]
    v_pk_fma_f32 v[50:51], v[58:59], v[70:71], v[50:51] op_sel:[0,0,0] op_sel_hi:[1,0,1]
    v_pk_fma_f32 v[48:49], v[60:61], v[70:71], v[48:49] op_sel:[0,1,0] op_sel_hi:[1,1,1]
    v_pk_fma_f32 v[50:51], v[62:63], v[70:71], v[50:51] op_sel:[0,1,0] op_sel_hi:[1,1,1]
    s_nop 0
    v_add_f32_dpp v64, v48, v48 row_ror:8 row_mask:0xf bank_mask:0x3
    v_add_f32_dpp v65, v49, v49 row_ror:8 row_mask:0xf bank_mask:0x3
    s_nop 0
    v_add_f32_dpp v64, v50, v50 row_ror:8 row_mask:0xf bank_mask:0xc
    v_add_f32_dpp v65, v51, v51 row_ror:8 row_mask:0xf bank_mask:0xc
    s_nop 0
    v_add_f32_dpp v66, v64, v64 row_ror:4 row_mask:0xf bank_mask:0xa
    v_add_f32_dpp v67, v65, v65 row_ror:4 row_mask:0xf bank_mask:0xa
    s_nop 0
    v_add_f32_dpp v66, v64, v64 row_ror:12 row_mask:0xf bank_mask:0x5
    v_add_f32_dpp v67, v65, v65 row_ror:12 row_mask:0xf bank_mask:0x5
    v_cvt_pk_bf16_f32 v66, v66, v66
    v_cvt_pk_bf16_f32 v67, v67, v67
    s_nop 0
    v_and_b32_dpp v16, v66, v2 quad_perm:[0,0,0,0] row_mask:0xf bank_mask:0xf
    v_and_b32_dpp v17, v66, v3 quad_perm:[0,0,0,0] row_mask:0xf bank_mask:0xf
    v_and_b32_dpp v18, v66, v4 quad_perm:[0,0,0,0] row_mask:0xf bank_mask:0xf
    v_and_b32_dpp v19, v66, v5 quad_perm:[0,0,0,0] row_mask:0xf bank_mask:0xf
    v_and_b32_dpp v20, v67, v2 quad_perm:[0,0,0,0] row_mask:0xf bank_mask:0xf
    v_and_b32_dpp v21, v67, v3 quad_perm:[0,0,0,0] row_mask:0xf bank_mask:0xf
    v_and_b32_dpp v22, v67, v4 quad_perm:[0,0,0,0] row_mask:0xf bank_mask:0xf
    v_and_b32_dpp v23, v67, v5 quad_perm:[0,0,0,0] row_mask:0xf bank_mask:0xf
    v_mfma_f32_16x16x32_bf16 v[8:11], v[16:19], v[80:83], 0
    v_and_b32_dpp v24, v66, v2 quad_perm:[1,1,1,1] row_mask:0xf bank_mask:0xf
    v_and_b32_dpp v25, v66, v3 quad_perm:[1,1,1,1] row_mask:0xf bank_mask:0xf
    v_and_b32_dpp v26, v66, v4 quad_perm:[1,1,1,1] row_mask:0xf bank_mask:0xf
    v_and_b32_dpp v27, v66, v5 quad_perm:[1,1,1,1] row_mask:0xf bank_mask:0xf
    v_mfma_f32_16x16x32_bf16 v[8:11], v[20:23], v[84:87], v[8:11]
    v_and_b32_dpp v28, v67, v2 quad_perm:[1,1,1,1] row_mask:0xf bank_mask:0xf
    v_and_b32_dpp v29, v67, v3 quad_perm:[1,1,1,1] row_mask:0xf bank_mask:0xf
    v_and_b32_dpp v30, v67, v4 quad_perm:[1,1,1,1] row_mask:0xf bank_mask:0xf
    v_and_b32_dpp v31, v67, v5 quad_perm:[1,1,1,1] row_mask:0xf bank_mask:0xf
    v_mfma_f32_16x16x32_bf16 v[8:11], v[24:27], v[88:91], v[8:11]
    v_and_b32_dpp v32, v66, v2 quad_perm:[2,2,2,2] row_mask:0xf bank_mask:0xf
    v_and_b32_dpp v33, v66, v3 quad_perm:[2,2,2,2] row_mask:0xf bank_mask:0xf
    v_and_b32_dpp v34, v66, v4 quad_perm:[2,2,2,2] row_mask:0xf bank_mask:0xf
    v_and_b32_dpp v35, v66, v5 quad_perm:[2,2,2,2] row_mask:0xf bank_mask:0xf
    v_mfma_f32_16x16x32_bf16 v[8:11], v[28:31], v[92:95], v[8:11]
    v_and_b32_dpp v36, v67, v2 quad_perm:[2,2,2,2] row_mask:0xf bank_mask:0xf
    v_and_b32_dpp v37, v67, v3 quad_perm:[2,2,2,2] row_mask:0xf bank_mask:0xf
    v_and_b32_dpp v38, v67, v4 quad_perm:[2,2,2,2] row_mask:0xf bank_mask:0xf
    v_and_b32_dpp v39, v67, v5 quad_perm:[2,2,2,2] row_mask:0xf bank_mask:0xf
    v_mfma_f32_16x16x32_bf16 v[8:11], v[32:35], v[96:99], v[8:11]
    v_and_b32_dpp v40, v66, v2 quad_perm:[3,3,3,3] row_mask:0xf bank_mask:0xf
    v_and_b32_dpp v41, v66, v3 quad_perm:[3,3,3,3] row_mask:0xf bank_mask:0xf
    v_and_b32_dpp v42, v66, v4 quad_perm:[3,3,3,3] row_mask:0xf bank_mask:0xf
    v_and_b32_dpp v43, v66, v5 quad_perm:[3,3,3,3] row_mask:0xf bank_mask:0xf
    v_mfma_f32_16x16x32_bf16 v[8:11], v[36:39], v[100:103], v[8:11]
    v_and_b32_dpp v44, v67, v2 quad_perm:[3,3,3,3] row_mask:0xf bank_mask:0xf
    v_and_b32_dpp v45, v67, v3 quad_perm:[3,3,3,3] row_mask:0xf bank_mask:0xf
    v_and_b32_dpp v46, v67, v4 quad_perm:[3,3,3,3] row_mask:0xf bank_mask:0xf
    v_and_b32_dpp v47, v67, v5 quad_perm:[3,3,3,3] row_mask:0xf bank_mask:0xf
    v_mfma_f32_16x16x32_bf16 v[8:11], v[40:43], v[104:107], v[8:11]
    s_nop 0
    v_mfma_f32_16x16x32_bf16 v[8:11], v[44:47], v[108:111], v[8:11]
    s_mov_b64 exec, s[56:57]
    s_nop 6
    ds_write_b128 v7, v[8:11] offset:0
    s_mov_b64 exec, -1
    s_waitcnt lgkmcnt(0)
    s_barrier
    s_endpgm
L_comm:
    v_lshrrev_b32 v26, 2, v1
    v_and_b32 v27, 3, v1
    v_mul_u32_u24 v22, 320, v27
    v_lshl_add_u32 v22, v26, 4, v22
    v_mov_b32 v23, 0xffffff00
    s_lshl_b32 s59, s39, 12
    s_add_u32 s59, s59, 0x10000
    s_lshl_b32 s60, s40, 8
    s_add_u32 s60, s60, s59
    v_lshl_add_u32 v26, v26, 4, s60
    v_lshl_add_u32 v27, v1, 4, s59
    v_lshlrev_b32 v28, 3, v1
    v_mov_b32 v48, 0
    v_mov_b32 v49, 0
    v_mov_b32 v50, 0
    v_mov_b32 v51, 0
    s_mov_b32 s60, 0x33333333
    s_mov_b32 s61, 0x33333333
    s_mov_b32 s62, 0x11111111
    s_mov_b32 s63, 0x11111111
    s_waitcnt lgkmcnt(0)
    s_barrier
    ds_read_b128 v[32:35], v22 offset:0
    ds_read_b128 v[36:39], v22 offset:1280
    ds_read_b128 v[40:43], v22 offset:2560
    ds_read_b128 v[44:47], v22 offset:3840
    s_mov_b64 exec, s[60:61]
    ds_read_b128 v[48:51], v22 offset:5120
    s_mov_b64 exec, -1
    s_waitcnt lgkmcnt(3)
    v_pk_add_f32 v[32:33], v[32:33], v[36:37]
    v_pk_add_f32 v[34:35], v[34:35], v[38:39]
    s_waitcnt lgkmcnt(1)
    v_pk_add_f32 v[40:41], v[40:41], v[44:45]
    v_pk_add_f32 v[42:43], v[42:43], v[46:47]
    v_pk_add_f32 v[32:33], v[32:33], v[40:41]
    v_pk_add_f32 v[34:35], v[34:35], v[42:43]
    s_waitcnt lgkmcnt(0)
    v_pk_add_f32 v[32:33], v[32:33], v[48:49]
    v_pk_add_f32 v[34:35], v[34:35], v[50:51]
    s_nop 0
    v_add_f32_dpp v32, v32, v32 quad_perm:[1,0,3,2] row_mask:0xf bank_mask:0xf
    v_add_f32_dpp v33, v33, v33 quad_perm:[1,0,3,2] row_mask:0xf bank_mask:0xf
    v_add_f32_dpp v34, v34, v34 quad_perm:[1,0,3,2] row_mask:0xf bank_mask:0xf
    v_add_f32_dpp v35, v35, v35 quad_perm:[1,0,3,2] row_mask:0xf bank_mask:0xf
    v_add_f32_dpp v32, v32, v32 quad_perm:[2,3,0,1] row_mask:0xf bank_mask:0xf
    v_add_f32_dpp v33, v33, v33 quad_perm:[2,3,0,1] row_mask:0xf bank_mask:0xf
    v_add_f32_dpp v34, v34, v34 quad_perm:[2,3,0,1] row_mask:0xf bank_mask:0xf
    v_add_f32_dpp v35, v35, v35 quad_perm:[2,3,0,1] row_mask:0xf bank_mask:0xf
    v_and_or_b32 v32, v32, v23, s31
    v_and_or_b32 v33, v33, v23, s32
    v_and_or_b32 v34, v34, v23, s33
    v_and_or_b32 v35, v35, v23, s34
    s_mov_b64 exec, s[62:63]
    global_store_dwordx4 v26, v[32:35], s[28:29]
    global_store_dwordx4 v26, v[32:35], s[100:101] sc1
    s_mov_b64 exec, -1
    s_mov_b64 s[44:45], -1
    s_mov_b64 s[46:47], -1
    s_mov_b64 s[48:49], -1
    s_mov_b64 s[50:51], -1
    s_movk_i32 s58, 0x2000
L_q_poll:
    s_mov_b64 exec, s[44:45]
    global_load_dwordx4 v[48:51], v27, s[0:1] offset:0 sc1
    s_mov_b64 exec, s[46:47]
    global_load_dwordx4 v[52:55], v27, s[0:1] offset:1024 sc1
    s_mov_b64 exec, s[48:49]
    global_load_dwordx4 v[56:59], v27, s[0:1] offset:2048 sc1
    s_mov_b64 exec, s[50:51]
    global_load_dwordx4 v[60:63], v27, s[0:1] offset:3072 sc1
L_q_poll_w:
    s_waitcnt vmcnt(3)
    s_mov_b64 exec, s[44:45]
    v_xor_b32 v48, s31, v48
    v_xor_b32 v49, s32, v49
    v_xor_b32 v50, s33, v50
    v_xor_b32 v51, s34, v51
    v_or3_b32 v25, v48, v49, v50
    v_or_b32 v25, v25, v51
    v_and_b32 v25, 0xff, v25
    v_cmp_ne_u32 s[44:45], 0, v25
    s_waitcnt vmcnt(2)
    s_mov_b64 exec, s[46:47]
    v_xor_b32 v52, s31, v52
    v_xor_b32 v53, s32, v53
    v_xor_b32 v54, s33, v54
    v_xor_b32 v55, s34, v55
    v_or3_b32 v25, v52, v53, v54
    v_or_b32 v25, v25, v55
    v_and_b32 v25, 0xff, v25
    v_cmp_ne_u32 s[46:47], 0, v25
    s_waitcnt vmcnt(1)
    s_mov_b64 exec, s[48:49]
    v_xor_b32 v56, s31, v56
    v_xor_b32 v57, s32, v57
    v_xor_b32 v58, s33, v58
    v_xor_b32 v59, s34, v59
    v_or3_b32 v25, v56, v57, v58
    v_or_b32 v25, v25, v59
    v_and_b32 v25, 0xff, v25
    v_cmp_ne_u32 s[48:49], 0, v25
    s_waitcnt vmcnt(0)
    s_mov_b64 exec, s[50:51]
    v_xor_b32 v60, s31, v60
    v_xor_b32 v61, s32, v61
    v_xor_b32 v62, s33, v62
    v_xor_b32 v63, s34, v63
    v_or3_b32 v25, v60, v61, v62
    v_or_b32 v25, v25, v63
    v_and_b32 v25, 0xff, v25
    v_cmp_ne_u32 s[50:51], 0, v25
    s_or_b64 vcc, s[44:45], s[46:47]
    s_or_b64 vcc, vcc, s[48:49]
    s_or_b64 vcc, vcc, s[50:51]
    s_cbranch_scc0 L_q_poll_x
    s_sub_u32 s58, s58, 1
    s_cbranch_scc1 L_q_poll_x
    s_cmp_lg_u32 s58, 0x1fc0
    s_cbranch_scc1 L_q_poll
    s_mov_b64 s[0:1], s[100:101]
    s_branch L_q_poll
L_q_poll_x:
    s_mov_b64 exec, -1
    v_pk_add_f32 v[48:49], v[48:49], v[52:53]
    v_pk_add_f32 v[56:57], v[56:57], v[60:61]
    v_pk_add_f32 v[50:51], v[50:51], v[54:55]
    v_pk_add_f32 v[58:59], v[58:59], v[62:63]
    v_pk_add_f32 v[48:49], v[48:49], v[56:57]
    v_pk_add_f32 v[50:51], v[50:51], v[58:59]
    v_cvt_pk_bf16_f32 v48, v48, v49
    v_cvt_pk_bf16_f32 v49, v50, v51
    ds_write_b64 v28, v[48:49] offset:5888
    s_waitcnt lgkmcnt(0)
    s_barrier
    s_max_u32 s59, s38, 9
    s_sub_u32 s59, s59, 9
    s_min_u32 s59, s59, 17
    s_lshr_b32 s60, s59, 1
    s_lshl3_add_u32 s61, s42, s60
    s_add_u32 s43, s42, 64
    s_cmp_lt_u32 s60, 8
    s_cselect_b32 s61, s61, s43
    s_and_b32 s59, s59, 1
    s_lshl1_add_u32 s43, s61, s59
    v_lshrrev_b32 v122, 3, v1
    v_and_b32 v123, 0x70, v6
    v_and_b32 v124, 3, v1
    v_and_b32 v120, 0x30, v1
    v_bfe_u32 v125, v1, 2, 1
    v_lshl_add_u32 v120, v125, 1, v120
    v_and_b32 v121, 1, v122
    v_add_u32 v120, v120, v121
    v_mov_b32 v121, 9216
    v_lshlrev_b32 v124, 4, v124
    v_mad_u32_u24 v120, v120, v121, v124
    v_mov_b32 v121, 4608
    v_mad_u32_u24 v121, v122, v121, v123
    s_mul_i32 s59, s3, 589824
    s_lshl_b32 s60, s43, 6
    s_add_u32 s59, s59, s60
    s_add_u32 s52, s16, s59
    s_addc_u32 s53, s17, 0
    s_mul_i32 s59, s43, 36864
    s_lshl_b32 s60, s3, 7
    s_add_u32 s59, s59, s60
    s_add_u32 s54, s20, s59
    s_addc_u32 s55, s21, 0
    s_sub_u32 s59, s38, 9
    s_cmp_lt_u32 s59, 18
    s_cbranch_scc0 L_c_nopre
    global_load_dwordx4 v[88:91], v120, s[52:53] nt
    s_add_u32 s52, s52, 36864
    s_addc_u32 s53, s53, 0
    global_load_dwordx4 v[92:95], v120, s[52:53] nt
    s_add_u32 s52, s52, 36864
    s_addc_u32 s53, s53, 0
    global_load_dwordx4 v[96:99], v120, s[52:53] nt
    s_add_u32 s52, s52, 36864
    s_addc_u32 s53, s53, 0
    global_load_dwordx4 v[100:103], v120, s[52:53] nt
    global_load_dwordx4 v[104:107], v121, s[54:55] offset:0 nt
    global_load_dwordx4 v[108:111], v121, s[54:55] offset:1152 nt
    global_load_dwordx4 v[112:115], v121, s[54:55] offset:2304 nt
    global_load_dwordx4 v[116:119], v121, s[54:55] offset:3456 nt
L_c_nopre:
    v_lshrrev_b32 v24, 5, v1
    v_lshlrev_b32 v24, 9, v24
    v_and_b32 v25, 15, v1
    v_lshl_add_u32 v24, v25, 5, v24
    v_bfe_u32 v25, v1, 4, 1
    v_lshl_add_u32 v24, v25, 4, v24
    s_lshl_b32 s59, s39, 14
    s_lshl_b32 s60, s40, 10
    s_add_u32 s59, s59, s60
    s_add_u32 s59, s59, 0x40000
    v_add_u32 v24, s59, v24
    v_lshlrev_b32 v25, 4, v1
    s_lshl4_add_u32 s59, s39, s40
    s_lshl_b32 s59, s59, 4
    s_add_u32 s59, s59, 0x30000
    v_mov_b32 v26, s59
    v_lshlrev_b32 v27, 3, v1
    v_lshrrev_b32 v28, 5, v1
    v_lshlrev_b32 v28, 5, v28
    v_and_b32 v29, 0x3c, v1
    s_movk_i32 s58, 0x2000
L_lp_poll:
    ds_read_b64 v[32:33], v27 offset:6400
    s_waitcnt lgkmcnt(0)
    v_cmp_gt_f32 vcc, 0, v33
    s_sub_u32 s58, s58, 1
    s_cbranch_scc1 L_lp_poll_x
    s_cbranch_vccnz L_lp_poll
L_lp_poll_x:
    v_max_f32_dpp v36, v32, v32 row_ror:4 row_mask:0xf bank_mask:0xf
    s_nop 1
    v_max_f32_dpp v36, v36, v36 row_ror:8 row_mask:0xf bank_mask:0xf
    v_mov_b32 v37, v36
    s_nop 1
    v_permlane16_swap_b32 v37, v36
    v_max_f32 v36, v36, v37
    v_sub_f32 v37, v32, v36
    v_mul_f32 v37, s35, v37
    v_exp_f32 v37, v37
    v_mov_b32 v32, v36
    v_mul_f32 v33, v33, v37
    ds_write_b32 v29, v37 offset:6912
    s_nop 0
    v_add_f32_dpp v33, v33, v33 quad_perm:[1,0,3,2] row_mask:0xf bank_mask:0xf
    s_nop 1
    v_add_f32_dpp v33, v33, v33 quad_perm:[2,3,0,1] row_mask:0xf bank_mask:0xf
    s_nop 1
    v_add_f32_dpp v33, v33, v33 row_ror:4 row_mask:0xf bank_mask:0xf
    s_nop 1
    v_add_f32_dpp v33, v33, v33 row_ror:8 row_mask:0xf bank_mask:0xf
    v_mov_b32 v38, v33
    s_nop 1
    v_permlane16_swap_b32 v38, v33
    v_add_f32 v33, v33, v38
    v_permlane32_swap_b32 v32, v34
    s_nop 0
    v_permlane32_swap_b32 v33, v35
    v_and_or_b32 v32, v32, v23, s31
    v_and_or_b32 v33, v33, v23, s32
    v_and_or_b32 v34, v34, v23, s33
    v_and_or_b32 v35, v35, v23, s34
    s_mov_b64 exec, 1
    global_store_dwordx4 v26, v[32:35], s[28:29]
    global_store_dwordx4 v26, v[32:35], s[100:101] sc1
    s_mov_b64 exec, -1
    ds_read_b128 v[64:67], v28 offset:6912
    ds_read_b128 v[68:71], v28 offset:6928
    v_lshrrev_b32 v26, 2, v1
    s_lshl_b32 s59, s38, 11
    s_lshl_b32 s60, s42, 8
    s_add_u32 s59, s59, s60
    s_add_u32 s59, s59, 0x80000
    v_lshl_add_u32 v29, v26, 4, s59
    s_barrier
    ds_read_b128 v[32:35], v25 offset:8192
    ds_read_b128 v[36:39], v25 offset:9216
    ds_read_b128 v[40:43], v25 offset:10240
    ds_read_b128 v[44:47], v25 offset:11264
    ds_read_b128 v[48:51], v25 offset:12288
    ds_read_b128 v[52:55], v25 offset:13312
    ds_read_b128 v[56:59], v25 offset:14336
    ds_read_b128 v[60:63], v25 offset:15360
    s_waitcnt lgkmcnt(7)
    v_pk_mul_f32 v[32:33], v[32:33], v[64:65] op_sel:[0,0] op_sel_hi:[1,0]
    v_pk_mul_f32 v[34:35], v[34:35], v[64:65] op_sel:[0,0] op_sel_hi:[1,0]
    s_waitcnt lgkmcnt(6)
    v_pk_mul_f32 v[36:37], v[36:37], v[64:65] op_sel:[0,1] op_sel_hi:[1,1]
    v_pk_mul_f32 v[38:39], v[38:39], v[64:65] op_sel:[0,1] op_sel_hi:[1,1]
    s_waitcnt lgkmcnt(5)
    v_pk_fma_f32 v[32:33], v[40:41], v[66:67], v[32:33] op_sel:[0,0,0] op_sel_hi:[1,0,1]
    v_pk_fma_f32 v[34:35], v[42:43], v[66:67], v[34:35] op_sel:[0,0,0] op_sel_hi:[1,0,1]
    s_waitcnt lgkmcnt(4)
    v_pk_fma_f32 v[36:37], v[44:45], v[66:67], v[36:37] op_sel:[0,1,0] op_sel_hi:[1,1,1]
    v_pk_fma_f32 v[38:39], v[46:47], v[66:67], v[38:39] op_sel:[0,1,0] op_sel_hi:[1,1,1]
    s_waitcnt lgkmcnt(3)
    v_pk_fma_f32 v[32:33], v[48:49], v[68:69], v[32:33] op_sel:[0,0,0] op_sel_hi:[1,0,1]
    v_pk_fma_f32 v[34:35], v[50:51], v[68:69], v[34:35] op_sel:[0,0,0] op_sel_hi:[1,0,1]
    s_waitcnt lgkmcnt(2)
    v_pk_fma_f32 v[36:37], v[52:53], v[68:69], v[36:37] op_sel:[0,1,0] op_sel_hi:[1,1,1]
    v_pk_fma_f32 v[38:39], v[54:55], v[68:69], v[38:39] op_sel:[0,1,0] op_sel_hi:[1,1,1]
    s_waitcnt lgkmcnt(1)
    v_pk_fma_f32 v[32:33], v[56:57], v[70:71], v[32:33] op_sel:[0,0,0] op_sel_hi:[1,0,1]
    v_pk_fma_f32 v[34:35], v[58:59], v[70:71], v[34:35] op_sel:[0,0,0] op_sel_hi:[1,0,1]
    s_waitcnt lgkmcnt(0)
    v_pk_fma_f32 v[36:37], v[60:61], v[70:71], v[36:37] op_sel:[0,1,0] op_sel_hi:[1,1,1]
    v_pk_fma_f32 v[38:39], v[62:63], v[70:71], v[38:39] op_sel:[0,1,0] op_sel_hi:[1,1,1]
    v_pk_add_f32 v[32:33], v[32:33], v[36:37]
    v_pk_add_f32 v[34:35], v[34:35], v[38:39]
    v_and_or_b32 v32, v32, v23, s31
    v_and_or_b32 v33, v33, v23, s32
    v_and_or_b32 v34, v34, v23, s33
    v_and_or_b32 v35, v35, v23, s34
    global_store_dwordx4 v24, v[32:35], s[28:29]
    global_store_dwordx4 v24, v[32:35], s[100:101] sc1
    s_cmp_lt_u32 s38, 9
    s_cbranch_scc1 L_c_wo
    s_cmp_lt_u32 s38, 27
    s_cbranch_scc1 L_c_mlp
    s_endpgm
L_c_wo:
    s_barrier
    s_barrier
    ds_read_b128 v[40:43], v22 offset:0
    ds_read_b128 v[44:47], v22 offset:1280
    ds_read_b128 v[48:51], v22 offset:2560
    ds_read_b128 v[52:55], v22 offset:3840
    s_waitcnt lgkmcnt(2)
    v_pk_add_f32 v[40:41], v[40:41], v[44:45]
    v_pk_add_f32 v[42:43], v[42:43], v[46:47]
    s_waitcnt lgkmcnt(0)
    v_pk_add_f32 v[48:49], v[48:49], v[52:53]
    v_pk_add_f32 v[50:51], v[50:51], v[54:55]
    v_pk_add_f32 v[40:41], v[40:41], v[48:49]
    v_pk_add_f32 v[42:43], v[42:43], v[50:51]
    s_nop 0
    v_add_f32_dpp v40, v40, v40 quad_perm:[1,0,3,2] row_mask:0xf bank_mask:0xf
    v_add_f32_dpp v41, v41, v41 quad_perm:[1,0,3,2] row_mask:0xf bank_mask:0xf
    v_add_f32_dpp v42, v42, v42 quad_perm:[1,0,3,2] row_mask:0xf bank_mask:0xf
    v_add_f32_dpp v43, v43, v43 quad_perm:[1,0,3,2] row_mask:0xf bank_mask:0xf
    v_add_f32_dpp v40, v40, v40 quad_perm:[2,3,0,1] row_mask:0xf bank_mask:0xf
    v_add_f32_dpp v41, v41, v41 quad_perm:[2,3,0,1] row_mask:0xf bank_mask:0xf
    v_add_f32_dpp v42, v42, v42 quad_perm:[2,3,0,1] row_mask:0xf bank_mask:0xf
    v_add_f32_dpp v43, v43, v43 quad_perm:[2,3,0,1] row_mask:0xf bank_mask:0xf
    v_and_or_b32 v40, v40, v23, s31
    v_and_or_b32 v41, v41, v23, s32
    v_and_or_b32 v42, v42, v23, s33
    v_and_or_b32 v43, v43, v23, s34
    s_mov_b64 exec, s[62:63]
    global_store_dwordx4 v29, v[40:43], s[28:29] sc1
    s_mov_b64 exec, -1
    s_endpgm
L_c_mlp:
    s_barrier
    s_waitcnt vmcnt(0)
L_mlp_w:
    v_lshrrev_b32 v78, 3, v1
    v_and_b32 v79, 0x70, v6
    v_and_b32 v80, 3, v1
    v_and_b32 v81, 4, v1
    s_lshl_b32 s60, s43, 6
    v_lshl_add_u32 v65, v78, 2, v80
    v_lshl_add_u32 v67, v65, 1, s60
    global_load_ushort v67, v67, s[18:19]
    v_lshlrev_b32 v65, 2, v65
    v_lshl_add_u32 v65, v81, 5, v65
    s_lshl_b32 s60, s3, 7
    v_and_b32 v60, 0x30, v1
    v_lshl_add_u32 v74, v60, 1, s60
    v_lshl_add_u32 v74, v80, 3, v74
    v_and_b32 v71, 1, v78
    v_lshl_add_u32 v74, v71, 2, v74
    global_load_dword v74, v74, s[4:5]
    v_lshrrev_b32 v71, 5, v1
    v_and_b32 v81, 16, v1
    v_lshrrev_b32 v72, 3, v81
    v_add_u32 v71, v71, v72
    s_lshl_b32 s59, s43, 3
    v_lshl_add_u32 v71, v71, 1, s59
    global_load_ushort v72, v71, s[22:23]
    s_lshl_b32 s59, s3, 11
    s_add_u32 s59, s59, 0x80000
    v_lshl_add_u32 v60, v60, 2, s59
    v_lshl_add_u32 v60, v80, 4, v60
    v_and_b32 v64, 12, v1
    v_lshl_add_u32 v60, v64, 6, v60
    v_lshrrev_b32 v64, 5, v1
    v_lshlrev_b32 v64, 7, v64
    v_lshl_add_u32 v64, v80, 5, v64
    s_lshl_b32 s61, s3, 8
    v_add3_u32 v64, v64, v81, s61
    s_mul_i32 s59, s43, 2304
    s_add_u32 s59, s59, s61
    s_add_u32 s59, s59, 0x90000
    v_lshl_add_u32 v63, v79, 1, v81
    v_add_u32 v63, s59, v63
    v_and_b32 v61, 1, v1
    v_lshlrev_b32 v61, 8, v61
    v_bfe_u32 v62, v1, 1, 3
    v_lshl_add_u32 v62, v62, 5, v61
    v_and_b32 v61, 4, v1
    v_lshlrev_b32 v61, 6, v61
    v_lshrrev_b32 v78, 4, v1
    v_lshl_add_u32 v61, v78, 2, v61
    s_lshl_b32 s59, s3, 4
    v_add_u32 v61, s59, v61
    s_mul_i32 s59, s43, 16
    s_add_u32 s59, s59, 0x90000
    v_mov_b32 v81, 2304
    v_mad_u32_u24 v68, v1, v81, s59
    v_add_u32 v69, 147456, v68
    v_and_b32 v70, 15, v1
    s_add_u32 s59, s59, 294912
    v_mad_u32_u24 v70, v70, v81, s59
    v_mov_b32 v66, 0x3ae38e39
    v_mov_b32 v73, 0xbdd2d3e8
    v_mov_b32 v82, 0xffffff00
    s_mov_b32 s48, 0xf0f0f0f0
    s_mov_b32 s49, 0xf0f0f0f0
    s_mov_b32 s14, 0x00110011
    s_mov_b32 s15, 0x00110011
    s_mov_b32 s96, 0x000f000f
    s_mov_b32 s97, 0x00f000f0
    v_and_b32 v84, s36, v2
    v_and_b32 v85, s36, v3
    v_and_b32 v86, s36, v4
    v_and_b32 v87, s36, v5
    s_waitcnt vmcnt(10)
    s_nop 0
    v_mfma_f32_16x16x32_bf16 v[8:11], v[84:87], v[88:91], 0
    s_waitcnt vmcnt(9)
    v_mfma_f32_16x16x32_bf16 v[8:11], v[84:87], v[92:95], v[8:11]
    s_waitcnt vmcnt(8)
    v_mfma_f32_16x16x32_bf16 v[8:11], v[84:87], v[96:99], v[8:11]
    s_waitcnt vmcnt(7)
    v_mfma_f32_16x16x32_bf16 v[8:11], v[84:87], v[100:103], v[8:11]
    s_nop 7
    v_add_f32_dpp v8, v8, v8 row_ror:8 row_mask:0xf bank_mask:0xf
    v_add_f32_dpp v9, v9, v9 row_ror:8 row_mask:0xf bank_mask:0xf
    v_add_f32_dpp v10, v10, v10 row_ror:8 row_mask:0xf bank_mask:0xf
    v_add_f32_dpp v11, v11, v11 row_ror:8 row_mask:0xf bank_mask:0xf
    s_mov_b64 exec, s[96:97]
    ds_write_b128 v64, v[8:11] offset:8192
    s_mov_b64 exec, -1
    s_waitcnt lgkmcnt(0)
    s_barrier
    ds_read2st64_b32 v[48:49], v65 offset0:32 offset1:33
    ds_read2st64_b32 v[50:51], v65 offset0:34 offset1:35
    ds_read2st64_b32 v[52:53], v65 offset0:36 offset1:37
    ds_read2st64_b32 v[54:55], v65 offset0:38 offset1:39
    ds_read_b32 v56, v65 offset:10240
    s_waitcnt lgkmcnt(3)
    v_pk_add_f32 v[48:49], v[48:49], v[50:51]
    s_waitcnt lgkmcnt(1)
    v_pk_add_f32 v[52:53], v[52:53], v[54:55]
    v_pk_add_f32 v[48:49], v[48:49], v[52:53]
    s_waitcnt lgkmcnt(0)
    v_add_f32 v48, v48, v56
    v_add_f32 v48, v48, v49
    s_nop 1
    v_add_f32_dpp v83, v48, v48 row_ror:4 row_mask:0xf bank_mask:0xa
    s_nop 1
    v_add_f32_dpp v83, v48, v48 row_ror:12 row_mask:0xf bank_mask:0x5
    global_load_dwordx4 v[48:51], v60, s[28:29] offset:0 sc1
    global_load_dwordx4 v[52:55], v60, s[28:29] offset:1024 sc1
    s_waitcnt vmcnt(2)
    v_and_b32 v75, 0xffff0000, v74
    v_lshlrev_b32 v74, 16, v74
    v_lshlrev_b32 v67, 16, v67
    v_lshlrev_b32 v72, 16, v72
    s_mov_b64 s[44:45], -1
    s_mov_b64 s[46:47], -1
    s_movk_i32 s58, 0x2000
    s_branch L_hp_poll_w
L_hp_poll:
    s_mov_b64 exec, s[44:45]
    global_load_dwordx4 v[48:51], v60, s[28:29] offset:0 sc1
    s_mov_b64 exec, s[46:47]
    global_load_dwordx4 v[52:55], v60, s[28:29] offset:1024 sc1
L_hp_poll_w:
    s_waitcnt vmcnt(1)
    s_mov_b64 exec, s[44:45]
    v_xor_b32 v48, s31, v48
    v_xor_b32 v49, s32, v49
    v_xor_b32 v50, s33, v50
    v_xor_b32 v51, s34, v51
    v_or3_b32 v12, v48, v49, v50
    v_or_b32 v12, v12, v51
    v_and_b32 v12, 0xff, v12
    v_cmp_ne_u32 s[44:45], 0, v12
    s_waitcnt vmcnt(0)
    s_mov_b64 exec, s[46:47]
    v_xor_b32 v52, s31, v52
    v_xor_b32 v53, s32, v53
    v_xor_b32 v54, s33, v54
    v_xor_b32 v55, s34, v55
    v_or3_b32 v12, v52, v53, v54
    v_or_b32 v12, v12, v55
    v_and_b32 v12, 0xff, v12
    v_cmp_ne_u32 s[46:47], 0, v12
    s_nop 0
    s_or_b64 vcc, s[44:45], s[46:47]
    s_cbranch_scc0 L_hp_poll_x
    s_sub_u32 s58, s58, 1
    s_cbranch_scc0 L_hp_poll
L_hp_poll_x:
    s_mov_b64 exec, -1
    v_pk_add_f32 v[48:49], v[48:49], v[52:53]
    v_pk_add_f32 v[50:51], v[50:51], v[54:55]
    s_nop 0
    v_add_f32_dpp v52, v48, v48 row_ror:8 row_mask:0xf bank_mask:0x3
    v_add_f32_dpp v53, v49, v49 row_ror:8 row_mask:0xf bank_mask:0x3
    s_nop 0
    v_add_f32_dpp v52, v50, v50 row_ror:8 row_mask:0xf bank_mask:0xc
    v_add_f32_dpp v53, v51, v51 row_ror:8 row_mask:0xf bank_mask:0xc
    s_nop 0
    v_add_f32_dpp v48, v52, v52 row_ror:4 row_mask:0xf bank_mask:0xa
    v_add_f32_dpp v49, v53, v53 row_ror:4 row_mask:0xf bank_mask:0xa
    s_nop 0
    v_add_f32_dpp v48, v52, v52 row_ror:12 row_mask:0xf bank_mask:0x5
    v_add_f32_dpp v49, v53, v53 row_ror:12 row_mask:0xf bank_mask:0x5
    v_cvt_pk_bf16_f32 v48, 0, v48
    v_cvt_pk_bf16_f32 v49, 0, v49
    v_add_f32 v48, v48, v74
    v_add_f32 v49, v49, v75
    v_cvt_pk_bf16_f32 v76, 0, v48
    v_cvt_pk_bf16_f32 v77, 0, v49
    v_cvt_pk_bf16_f32 v48, v48, v48
    v_cvt_pk_bf16_f32 v49, v49, v49
    v_add_f32 v50, v76, v77
    v_mul_f32 v51, v76, v76
    v_fmac_f32 v51, v77, v77
    v_cndmask_b32 v50, v50, v51, s[48:49]
    v_and_b32_dpp v16, v48, v2 quad_perm:[0,0,0,0] row_mask:0xf bank_mask:0xf
    v_and_b32_dpp v17, v48, v3 quad_perm:[0,0,0,0] row_mask:0xf bank_mask:0xf
    v_add_f32_dpp v50, v50, v50 quad_perm:[1,0,3,2] row_mask:0xf bank_mask:0xf
    v_and_b32_dpp v18, v48, v4 quad_perm:[0,0,0,0] row_mask:0xf bank_mask:0xf
    v_and_b32_dpp v19, v48, v5 quad_perm:[0,0,0,0] row_mask:0xf bank_mask:0xf
    v_add_f32_dpp v50, v50, v50 quad_perm:[2,3,0,1] row_mask:0xf bank_mask:0xf
    v_and_b32_dpp v20, v49, v2 quad_perm:[0,0,0,0] row_mask:0xf bank_mask:0xf
    v_and_b32_dpp v21, v49, v3 quad_perm:[0,0,0,0] row_mask:0xf bank_mask:0xf
    v_add_f32_dpp v50, v50, v50 row_ror:8 row_mask:0xf bank_mask:0xf
    v_and_b32_dpp v22, v49, v4 quad_perm:[0,0,0,0] row_mask:0xf bank_mask:0xf
    v_and_b32_dpp v23, v49, v5 quad_perm:[0,0,0,0] row_mask:0xf bank_mask:0xf
    v_mfma_f32_16x16x32_bf16 v[8:11], v[16:19], v[88:91], 0
    v_and_b32_dpp v24, v48, v2 quad_perm:[1,1,1,1] row_mask:0xf bank_mask:0xf
    v_and_b32_dpp v25, v48, v3 quad_perm:[1,1,1,1] row_mask:0xf bank_mask:0xf
    v_and_b32_dpp v26, v48, v4 quad_perm:[1,1,1,1] row_mask:0xf bank_mask:0xf
    v_and_b32_dpp v27, v48, v5 quad_perm:[1,1,1,1] row_mask:0xf bank_mask:0xf
    v_mfma_f32_16x16x32_bf16 v[12:15], v[20:23], v[88:91], 0
    v_and_b32_dpp v28, v49, v2 quad_perm:[1,1,1,1] row_mask:0xf bank_mask:0xf
    v_and_b32_dpp v29, v49, v3 quad_perm:[1,1,1,1] row_mask:0xf bank_mask:0xf
    v_and_b32_dpp v30, v49, v4 quad_perm:[1,1,1,1] row_mask:0xf bank_mask:0xf
    v_and_b32_dpp v31, v49, v5 quad_perm:[1,1,1,1] row_mask:0xf bank_mask:0xf
    v_mfma_f32_16x16x32_bf16 v[8:11], v[24:27], v[92:95], v[8:11]
    v_and_b32_dpp v32, v48, v2 quad_perm:[2,2,2,2] row_mask:0xf bank_mask:0xf
    v_and_b32_dpp v33, v48, v3 quad_perm:[2,2,2,2] row_mask:0xf bank_mask:0xf
    v_and_b32_dpp v34, v48, v4 quad_perm:[2,2,2,2] row_mask:0xf bank_mask:0xf
    v_and_b32_dpp v35, v48, v5 quad_perm:[2,2,2,2] row_mask:0xf bank_mask:0xf
    v_mfma_f32_16x16x32_bf16 v[12:15], v[28:31], v[92:95], v[12:15]
    v_and_b32_dpp v36, v49, v2 quad_perm:[2,2,2,2] row_mask:0xf bank_mask:0xf
    v_and_b32_dpp v37, v49, v3 quad_perm:[2,2,2,2] row_mask:0xf bank_mask:0xf
    v_and_b32_dpp v38, v49, v4 quad_perm:[2,2,2,2] row_mask:0xf bank_mask:0xf
    v_and_b32_dpp v39, v49, v5 quad_perm:[2,2,2,2] row_mask:0xf bank_mask:0xf
    v_mfma_f32_16x16x32_bf16 v[8:11], v[32:35], v[96:99], v[8:11]
    v_and_b32_dpp v40, v48, v2 quad_perm:[3,3,3,3] row_mask:0xf bank_mask:0xf
    v_and_b32_dpp v41, v48, v3 quad_perm:[3,3,3,3] row_mask:0xf bank_mask:0xf
    v_and_b32_dpp v42, v48, v4 quad_perm:[3,3,3,3] row_mask:0xf bank_mask:0xf
    v_and_b32_dpp v43, v48, v5 quad_perm:[3,3,3,3] row_mask:0xf bank_mask:0xf
    v_mfma_f32_16x16x32_bf16 v[12:15], v[36:39], v[96:99], v[12:15]
    v_and_b32_dpp v44, v49, v2 quad_perm:[3,3,3,3] row_mask:0xf bank_mask:0xf
    v_and_b32_dpp v45, v49, v3 quad_perm:[3,3,3,3] row_mask:0xf bank_mask:0xf
    v_and_b32_dpp v46, v49, v4 quad_perm:[3,3,3,3] row_mask:0xf bank_mask:0xf
    v_and_b32_dpp v47, v49, v5 quad_perm:[3,3,3,3] row_mask:0xf bank_mask:0xf
    v_mfma_f32_16x16x32_bf16 v[8:11], v[40:43], v[100:103], v[8:11]
    s_nop 0
    v_mfma_f32_16x16x32_bf16 v[12:15], v[44:47], v[100:103], v[12:15]
    s_mov_b64 exec, s[14:15]
    ds_write_b32 v61, v50 offset:7168
    s_mov_b64 exec, -1
    s_nop 4
    v_add_f32_dpp v8, v12, v8 row_ror:8 row_mask:0xf bank_mask:0xf
    v_add_f32_dpp v9, v13, v9 row_ror:8 row_mask:0xf bank_mask:0xf
    v_add_f32_dpp v10, v14, v10 row_ror:8 row_mask:0xf bank_mask:0xf
    v_add_f32_dpp v11, v15, v11 row_ror:8 row_mask:0xf bank_mask:0xf
    s_mov_b64 exec, s[96:97]
    ds_write_b128 v64, v[8:11] offset:0
    s_mov_b64 exec, -1
    s_waitcnt lgkmcnt(0)
    s_barrier
    ds_read_b128 v[16:19], v62 offset:7168
    ds_read_b128 v[20:23], v62 offset:7184
    ds_read2st64_b32 v[48:49], v65 offset0:0 offset1:1
    ds_read2st64_b32 v[50:51], v65 offset0:2 offset1:3
    ds_read2st64_b32 v[52:53], v65 offset0:4 offset1:5
    ds_read2st64_b32 v[54:55], v65 offset0:6 offset1:7
    ds_read_b32 v56, v65 offset:2048
    s_waitcnt lgkmcnt(5)
    v_pk_add_f32 v[16:17], v[16:17], v[20:21]
    v_pk_add_f32 v[18:19], v[18:19], v[22:23]
    v_pk_add_f32 v[16:17], v[16:17], v[18:19]
    v_add_f32 v24, v16, v17
    s_waitcnt lgkmcnt(3)
    v_pk_add_f32 v[48:49], v[48:49], v[50:51]
    v_add_f32_dpp v24, v24, v24 quad_perm:[2,3,0,1] row_mask:0xf bank_mask:0xf
    s_waitcnt lgkmcnt(1)
    v_pk_add_f32 v[52:53], v[52:53], v[54:55]
    v_add_f32_dpp v24, v24, v24 row_ror:4 row_mask:0xf bank_mask:0xf
    v_pk_add_f32 v[48:49], v[48:49], v[52:53]
    s_waitcnt lgkmcnt(0)
    v_add_f32_dpp v24, v24, v24 row_ror:8 row_mask:0xf bank_mask:0xf
    v_add_f32 v48, v48, v56
    v_add_f32 v48, v48, v49
    v_mov_b32_dpp v25, v24 quad_perm:[1,1,3,3] row_mask:0xf bank_mask:0xf
    v_mov_b32_dpp v24, v24 quad_perm:[0,0,2,2] row_mask:0xf bank_mask:0xf
    v_mul_f32 v26, v24, v66
    v_mul_f32 v27, v25, v66
    v_fma_f32 v27, -v26, v26, v27
    v_cvt_pk_bf16_f32 v28, 0, v26
    v_cvt_pk_bf16_f32 v31, 0, v27
    v_add_f32 v31, 0x3727c5ac, v31
    v_cvt_pk_bf16_f32 v31, 0, v31
    v_sqrt_f32 v29, v31
    v_sub_f32 v26, v26, v28
    v_cvt_pk_bf16_f32 v29, 0, v29
    v_rcp_f32 v30, v29
    v_add_f32_dpp v50, v48, v48 row_ror:4 row_mask:0xf bank_mask:0xa
    v_mul_f32 v27, v27, v30
    v_mul_f32 v26, v26, v30
    v_mul_f32 v27, v27, v30
    v_cvt_pk_bf16_f32 v32, 0, v26
    v_cvt_pk_bf16_f32 v31, 0, v27
    v_fma_f32 v32, v28, v30, v32
    v_add_f32 v31, 0x3727c5ac, v31
    v_mul_f32 v32, v32, v83
    v_cvt_pk_bf16_f32 v31, 0, v31
    v_sqrt_f32 v31, v31
    v_add_f32_dpp v50, v48, v48 row_ror:12 row_mask:0xf bank_mask:0x5
    v_cvt_pk_bf16_f32 v31, 0, v31
    v_rcp_f32 v33, v31
    v_fma_f32 v50, v50, v30, -v32
    v_mul_f32 v50, v50, v33
    v_cvt_pk_bf16_f32 v50, 0, v50
    v_add_f32 v50, v50, v67
    v_cvt_pk_bf16_f32 v50, 0, v50
    v_mul_f32 v51, v50, v50
    v_fmaak_f32 v51, v51, v73, 0xc0135761
    v_mul_f32 v51, v51, v50
    v_exp_f32 v51, v51
    s_nop 0
    v_add_f32 v51, 1.0, v51
    v_rcp_f32 v51, v51
    s_nop 0
    v_mul_f32 v50, v50, v51
    v_cvt_pk_bf16_f32 v50, v50, v50
    s_nop 1
    v_and_b32_dpp v16, v50, v2 quad_perm:[0,0,0,0] row_mask:0xf bank_mask:0xf
    v_and_b32_dpp v17, v50, v3 quad_perm:[0,0,0,0] row_mask:0xf bank_mask:0xf
    v_and_b32_dpp v18, v50, v4 quad_perm:[0,0,0,0] row_mask:0xf bank_mask:0xf
    v_and_b32_dpp v19, v50, v5 quad_perm:[0,0,0,0] row_mask:0xf bank_mask:0xf
    v_and_b32_dpp v20, v50, v2 quad_perm:[1,1,1,1] row_mask:0xf bank_mask:0xf
    v_and_b32_dpp v21, v50, v3 quad_perm:[1,1,1,1] row_mask:0xf bank_mask:0xf
    v_and_b32_dpp v22, v50, v4 quad_perm:[1,1,1,1] row_mask:0xf bank_mask:0xf
    v_and_b32_dpp v23, v50, v5 quad_perm:[1,1,1,1] row_mask:0xf bank_mask:0xf
    v_mfma_f32_16x16x32_bf16 v[8:11], v[16:19], v[104:107], 0
    v_and_b32_dpp v24, v50, v2 quad_perm:[2,2,2,2] row_mask:0xf bank_mask:0xf
    v_and_b32_dpp v25, v50, v3 quad_perm:[2,2,2,2] row_mask:0xf bank_mask:0xf
    v_and_b32_dpp v26, v50, v4 quad_perm:[2,2,2,2] row_mask:0xf bank_mask:0xf
    v_and_b32_dpp v27, v50, v5 quad_perm:[2,2,2,2] row_mask:0xf bank_mask:0xf
    v_mfma_f32_16x16x32_bf16 v[8:11], v[20:23], v[108:111], v[8:11]
    v_and_b32_dpp v28, v50, v2 quad_perm:[3,3,3,3] row_mask:0xf bank_mask:0xf
    v_and_b32_dpp v29, v50, v3 quad_perm:[3,3,3,3] row_mask:0xf bank_mask:0xf
    v_and_b32_dpp v30, v50, v4 quad_perm:[3,3,3,3] row_mask:0xf bank_mask:0xf
    v_and_b32_dpp v31, v50, v5 quad_perm:[3,3,3,3] row_mask:0xf bank_mask:0xf
    v_mfma_f32_16x16x32_bf16 v[8:11], v[24:27], v[112:115], v[8:11]
    s_nop 0
    v_mfma_f32_16x16x32_bf16 v[8:11], v[28:31], v[116:119], v[8:11]
    s_lshr_b32 s59, s43, 4
    s_nop 6
    v_permlane32_swap_b32 v8, v52
    v_permlane32_swap_b32 v9, v53
    v_permlane32_swap_b32 v10, v54
    v_permlane32_swap_b32 v11, v55
    v_add_f32_dpp v8, v52, v8 row_ror:8 row_mask:0xf bank_mask:0xf
    v_add_f32_dpp v9, v53, v9 row_ror:8 row_mask:0xf bank_mask:0xf
    v_add_f32_dpp v10, v54, v10 row_ror:8 row_mask:0xf bank_mask:0xf
    v_add_f32_dpp v11, v55, v11 row_ror:8 row_mask:0xf bank_mask:0xf
    v_and_or_b32 v8, v8, v82, s31
    v_and_or_b32 v9, v9, v82, s32
    v_and_or_b32 v10, v10, v82, s33
    v_and_or_b32 v11, v11, v82, s34
    s_mov_b64 exec, 0x00ff00ff
    global_store_dwordx4 v63, v[8:11], s[28:29] sc1
    s_mov_b64 exec, -1
    s_barrier
    s_cmp_lg_u32 s59, s3
    s_cbranch_scc1 L_m_done
    s_and_b32 s59, s43, 12
    s_and_b32 s60, s43, 3
    s_lshl2_add_u32 s59, s59, s60
    v_readlane_b32 s60, v76, s59
    v_readlane_b32 s61, v77, s59
    s_add_u32 s59, s59, 8
    v_readlane_b32 s62, v76, s59
    v_readlane_b32 s63, v77, s59
    v_writelane_b32 v76, s60, 0
    v_writelane_b32 v76, s62, 16
    v_writelane_b32 v76, s61, 32
    v_writelane_b32 v76, s63, 48
    s_mov_b32 s60, 0x00010001
    s_mov_b32 s61, 0x00010001
    s_mov_b64 s[44:45], -1
    s_mov_b64 s[46:47], -1
    s_mov_b64 s[52:53], 0xffff
    s_movk_i32 s58, 0x2000
L_ff_poll:
    s_mov_b64 exec, s[44:45]
    global_load_dwordx4 v[48:51], v68, s[28:29] sc1
    s_mov_b64 exec, s[46:47]
    global_load_dwordx4 v[52:55], v69, s[28:29] sc1
    s_mov_b64 exec, s[52:53]
    global_load_dwordx4 v[56:59], v70, s[28:29] sc1
L_ff_poll_w:
    s_waitcnt vmcnt(2)
    s_mov_b64 exec, s[44:45]
    v_xor_b32 v48, s31, v48
    v_xor_b32 v49, s32, v49
    v_xor_b32 v50, s33, v50
    v_xor_b32 v51, s34, v51
    v_or3_b32 v12, v48, v49, v50
    v_or_b32 v12, v12, v51
    v_and_b32 v12, 0xff, v12
    v_cmp_ne_u32 s[44:45], 0, v12
    s_waitcnt vmcnt(1)
    s_mov_b64 exec, s[46:47]
    v_xor_b32 v52, s31, v52
    v_xor_b32 v53, s32, v53
    v_xor_b32 v54, s33, v54
    v_xor_b32 v55, s34, v55
    v_or3_b32 v12, v52, v53, v54
    v_or_b32 v12, v12, v55
    v_and_b32 v12, 0xff, v12
    v_cmp_ne_u32 s[46:47], 0, v12
    s_waitcnt vmcnt(0)
    s_mov_b64 exec, s[52:53]
    v_xor_b32 v56, s31, v56
    v_xor_b32 v57, s32, v57
    v_xor_b32 v58, s33, v58
    v_xor_b32 v59, s34, v59
    v_or3_b32 v12, v56, v57, v58
    v_or_b32 v12, v12, v59
    v_and_b32 v12, 0xff, v12
    v_cmp_ne_u32 s[52:53], 0, v12
    s_or_b64 vcc, s[44:45], s[46:47]
    s_or_b64 vcc, vcc, s[52:53]
    s_cbranch_scc0 L_ff_poll_x
    s_sub_u32 s58, s58, 1
    s_cbranch_scc0 L_ff_poll
L_ff_poll_x:
    s_mov_b64 exec, -1
    v_pk_add_f32 v[48:49], v[48:49], v[52:53]
    v_pk_add_f32 v[50:51], v[50:51], v[54:55]
    s_mov_b64 exec, 0xffff
    v_pk_add_f32 v[48:49], v[48:49], v[56:57]
    v_pk_add_f32 v[50:51], v[50:51], v[58:59]
    s_mov_b64 exec, -1
    v_permlane32_swap_b32 v48, v49
    v_permlane32_swap_b32 v50, v51
    v_add_f32 v48, v48, v49
    v_add_f32 v50, v50, v51
    s_nop 1
    v_permlane16_swap_b32 v48, v50
    v_add_f32 v48, v48, v50
    s_nop 1
    v_add_f32_dpp v48, v48, v48 quad_perm:[1,0,3,2] row_mask:0xf bank_mask:0xf
    s_nop 1
    v_add_f32_dpp v48, v48, v48 quad_perm:[2,3,0,1] row_mask:0xf bank_mask:0xf
    s_nop 1
    v_add_f32_dpp v48, v48, v48 row_half_mirror row_mask:0xf bank_mask:0xf
    s_nop 1
    v_add_f32_dpp v48, v48, v48 row_mirror row_mask:0xf bank_mask:0xf
    v_cvt_pk_bf16_f32 v48, 0, v48
    v_add_f32 v48, v48, v72
    v_cvt_pk_bf16_f32 v48, 0, v48
    v_add_f32 v48, v48, v76
    v_cvt_pk_bf16_f32 v48, v48, v48
    s_mov_b64 exec, s[60:61]
    global_store_short v71, v48, s[24:25]
    s_cmp_lg_u32 s43, 0
    s_cbranch_scc1 L_m_done
    s_mov_b64 exec, 1
    v_mov_b32 v49, 0
    v_mov_b32 v50, s30
    global_store_dword v49, v50, s[28:29] sc1
L_m_done:
    s_mov_b64 exec, -1
L_end:
    s_endpgm
.section .rodata,"a"
.p2align 6
.amdhsa_kernel sequential_preLN__sliding_block_cached__mixer_channel_mlp__decode_kernel
  .amdhsa_next_free_vgpr 168
  .amdhsa_next_free_sgpr 102
  .amdhsa_accum_offset 168
  .amdhsa_group_segment_fixed_size 0
  .amdhsa_kernarg_size 104
  .amdhsa_user_sgpr_count 2
  .amdhsa_user_sgpr_kernarg_segment_ptr 1
  .amdhsa_system_sgpr_workgroup_id_x 1
.end_amdhsa_kernel
```
